```python
import torch

def _softmax(x, axis=-1):
    return torch.softmax(x, dim=axis)
def _gelu(x):
    return torch.nn.functional.gelu(x, approximate="tanh")
def _silu(x):
    return torch.nn.functional.silu(x)
def _sigmoid(x):
    return torch.sigmoid(x)
def _layernorm(x, axis=-1, eps=1e-5):
    m = x.mean(dim=axis, keepdim=True)
    v = x.var(dim=axis, keepdim=True, unbiased=False)
    return (x - m) / torch.sqrt(v + eps)
def _scatter_add(tgt, idx, src, axis=0):
    return tgt.clone().index_add_(axis, idx, src)
def _segment_sum(src, seg, n):
    out = torch.zeros((n,) + src.shape[1:], dtype=src.dtype)
    return out.index_add_(0, seg, src)
def _pad(x, pw):
    flat = tuple(v for pair in reversed(pw) for v in pair)
    return torch.nn.functional.pad(x, flat)

kernel_name = 'gated_mix__ssm_conv_s4__mixer_token_mlp__prompt'

def setup_inputs():

    _w = (lambda a: (lambda t: t.to(torch.bfloat16) if t.is_floating_point() else t)(torch.as_tensor(a)))
    def _A_setup():
        B, L, D, N = 1, 2048, 512, 128
        A_re = -(lambda _x: torch.exp(torch.as_tensor(_x)))((lambda *s: torch.randn(*s, dtype=torch.bfloat16) * 3.2)(D, N))
        A_im = torch.pi * (lambda *s: torch.randn(*s, dtype=torch.bfloat16) * 0.05)(D, N)
        B_re = (lambda *s: torch.randn(*s, dtype=torch.bfloat16) * 0.1)(D, N)
        B_im = (lambda *s: torch.randn(*s, dtype=torch.bfloat16) * 0.1)(D, N)
        C_re = (lambda *s: torch.randn(*s, dtype=torch.bfloat16) * 0.1)(D, N)
        C_im = (lambda *s: torch.randn(*s, dtype=torch.bfloat16) * 0.1)(D, N)
        log_dt = (lambda *s: torch.randn(*s, dtype=torch.bfloat16) * 0.05)(D) * 0.5 - 4.0
        Dskip = (lambda *s: torch.randn(*s, dtype=torch.bfloat16) * 0.05)(D)
        return {
            "u": _w((lambda *s: torch.randn(*s, dtype=torch.bfloat16) * 0.05)(B, L, D)),
            "A_re": _w(A_re),
            "A_im": _w(A_im),
            "B_re": _w(B_re),
            "B_im": _w(B_im),
            "C_re": _w(C_re),
            "C_im": _w(C_im),
            "log_dt": _w(log_dt),
            "Dskip": _w(Dskip),
        }
    _A_in = _A_setup()

    def _B_setup():
        B, S, D, F = 1, 2048, 512, 1792
        return {
            "x": _w((lambda *s: torch.randn(*s, dtype=torch.bfloat16) * 0.05)(B, S, D)),
            "w1": _w((lambda *s: torch.randn(*s, dtype=torch.bfloat16) * 0.2)(S, F) * (S ** -0.5)),
            "b1": _w((lambda *s: torch.randn(*s, dtype=torch.bfloat16) * 3.2)(F) * 0.02),
            "w2": _w((lambda *s: torch.randn(*s, dtype=torch.bfloat16) * 0.05)(F, S) * (F ** -0.5)),
            "b2": _w((lambda *s: torch.randn(*s, dtype=torch.bfloat16) * 0.1)(S) * 0.02),
        }
    _B_in = _B_setup()

    return {
        "A_u": _A_in["u"],
        "A_A_re": _A_in["A_re"],
        "A_A_im": _A_in["A_im"],
        "A_B_re": _A_in["B_re"],
        "A_B_im": _A_in["B_im"],
        "A_C_re": _A_in["C_re"],
        "A_C_im": _A_in["C_im"],
        "A_log_dt": _A_in["log_dt"],
        "A_Dskip": _A_in["Dskip"],
        "B_x": _B_in["x"],
        "B_w1": _B_in["w1"],
        "B_b1": _B_in["b1"],
        "B_w2": _B_in["w2"],
        "B_b2": _B_in["b2"],
        "gate_w": _w((lambda *s: torch.randn(*s, dtype=torch.bfloat16) * 0.05)(512) * 16.0),
    }

def reference(A_u, A_A_re, A_A_im, A_B_re, A_B_im, A_C_re, A_C_im, A_log_dt, A_Dskip, B_x, B_w1, B_b1, B_w2, B_b2, gate_w):
    def _A_ref(u, A_re, A_im, B_re, B_im, C_re, C_im, log_dt, Dskip):
        Bsz, L, D = u.shape
        dt = torch.exp(log_dt)[:, None]
        A = A_re + 1j * A_im
        Bc = B_re + 1j * B_im
        Cc = C_re + 1j * C_im
        logdA = dt * A
        dB = dt * Bc
        l = (lambda x, dt: x.to(dt))(torch.arange(L), A_re.dtype)
        P = torch.exp(logdA[:, :, None] * l[None, None, :])
        K = torch.einsum("dn,dnl,dn->dl", Cc, P, dB).real
        L2 = 2 * L
        Kp = _pad(K, ((0, 0), (0, L)))
        up = (lambda x, *d: x.permute(*d))(u, 0, 2, 1)
        up = _pad(up, ((0, 0), (0, 0), (0, L)))
        Kf = (lambda x, axes=(-2,-1): torch.fft.rfft2(x.float(), dim=axes))(Kp[:, None, :], axes=(-2, -1))
        Uf = (lambda x, axes=(-2,-1): torch.fft.rfft2(x.float(), dim=axes))(up[:, :, None, :], axes=(-2, -1))
        Yf = Uf * Kf[None, :, :, :]
        y = (lambda x, s, axes=(-2,-1): torch.fft.irfft2(x, s=s, dim=axes).to(torch.bfloat16))(Yf, (1, L2), axes=(-2, -1))[:, :, 0, :L]
        y = (lambda x, *d: x.permute(*d))(y, 0, 2, 1) + u * Dskip[None, None, :]
        return y

    def _B_ref(x, w1, b1, w2, b2):
        B, S, D = x.shape
        h = _layernorm(x, axis=-1)
        u = torch.einsum("bsd,sf->bdf", h, w1) + b1
        u = _gelu(u)
        y = torch.einsum("bdf,fs->bds", u, w2) + b2
        return (lambda x, *d: x.permute(*d))(y, 0, 2, 1)

    x = A_u
    g = _sigmoid((x * gate_w).sum(-1, keepdims=True))
    a = _A_ref(x, A_A_re, A_A_im, A_B_re, A_B_im, A_C_re, A_C_im, A_log_dt, A_Dskip)
    b = _B_ref(x, B_w1, B_b1, B_w2, B_b2)
    return g * a + (1 - g) * b
```

```asm
; @launch kernel=k1_prep_kernel grid=(768,1,1) block=(256,1,1) lds=45872
; @launch kernel=k2_gemm1_conv_kernel grid=(736,1,1) block=(256,1,1) lds=52480
; @launch kernel=k3_gemm2_kernel grid=(256,1,1) block=(256,1,1) lds=74752
.amdgcn_target "amdgcn-amd-amdhsa--gfx950"
.text
.globl k1_prep_kernel
.p2align 8
.type k1_prep_kernel,@function
k1_prep_kernel:
    s_cmp_ge_u32 s2, 768
    s_cbranch_scc1 L_k1_exit
    s_cmp_ge_u32 s2, 512
    s_cbranch_scc1 L_k1_prep
    s_load_dwordx4 s[28:31], s[0:1], 8
    s_load_dwordx4 s[32:35], s[0:1], 24
    s_load_dwordx4 s[36:39], s[0:1], 40
    s_load_dwordx2 s[40:41], s[0:1], 56
    s_load_dwordx2 s[4:5], s[0:1], 136
    s_load_dwordx2 s[6:7], s[0:1], 80
    v_lshrrev_b32 v1, 6, v0
    v_and_b32 v2, 63, v0
    v_readfirstlane_b32 s3, v1
    v_and_b32 v3, 127, v0
    v_lshlrev_b32 v4, 1, v3
    s_lshl_b32 s20, s2, 8
    s_lshl_b32 s25, s2, 1
    v_mov_b32 v6, 0
    s_waitcnt lgkmcnt(0)
    s_mov_b32 s44, s28
    s_mov_b32 s45, s29
    s_mov_b32 s46, 0x20000
    s_mov_b32 s47, 0x00020000
    buffer_load_ushort v10, v4, s[44:47], s20 offen
    s_mov_b32 s48, s30
    s_mov_b32 s49, s31
    s_mov_b32 s50, 0x20000
    s_mov_b32 s51, 0x00020000
    buffer_load_ushort v11, v4, s[48:51], s20 offen
    s_mov_b32 s52, s32
    s_mov_b32 s53, s33
    s_mov_b32 s54, 0x20000
    s_mov_b32 s55, 0x00020000
    buffer_load_ushort v12, v4, s[52:55], s20 offen
    s_mov_b32 s56, s34
    s_mov_b32 s57, s35
    s_mov_b32 s58, 0x20000
    s_mov_b32 s59, 0x00020000
    buffer_load_ushort v13, v4, s[56:59], s20 offen
    s_mov_b32 s60, s36
    s_mov_b32 s61, s37
    s_mov_b32 s62, 0x20000
    s_mov_b32 s63, 0x00020000
    buffer_load_ushort v14, v4, s[60:63], s20 offen
    s_mov_b32 s64, s38
    s_mov_b32 s65, s39
    s_mov_b32 s66, 0x20000
    s_mov_b32 s67, 0x00020000
    buffer_load_ushort v15, v4, s[64:67], s20 offen
    s_mov_b32 s12, s40
    s_mov_b32 s13, s41
    s_mov_b32 s14, 0x400
    s_mov_b32 s15, 0x00020000
    buffer_load_ushort v16, v6, s[12:15], s25 offen
    s_mov_b32 s8, s4
    s_mov_b32 s9, s5
    s_mov_b32 s10, 0x10000000
    s_mov_b32 s11, 0x00020000
    s_cmp_ge_u32 s3, 2
    s_cselect_b32 s26, 0, 21648
    s_cselect_b32 s27, 0x41800000, 0x3f800000
    s_cselect_b32 s36, 0x3e22f983, 0xbe22f983
    v_lshlrev_b32 v8, 2, v3
    v_add_u32 v8, s26, v8
    v_lshlrev_b32 v28, 3, v0
    v_sub_u32 v28, 2047, v28
    s_mov_b32 s28, 0xffff
    s_mov_b32 s29, 17024
    v_subrev_u32 v48, 0, v28
    v_cvt_f32_u32 v56, v48
    v_subrev_u32 v49, 1, v28
    v_cvt_f32_u32 v57, v49
    v_subrev_u32 v50, 2, v28
    v_cvt_f32_u32 v58, v50
    v_subrev_u32 v51, 3, v28
    v_cvt_f32_u32 v59, v51
    v_subrev_u32 v52, 4, v28
    v_cvt_f32_u32 v60, v52
    v_subrev_u32 v53, 5, v28
    v_cvt_f32_u32 v61, v53
    v_subrev_u32 v54, 6, v28
    v_cvt_f32_u32 v62, v54
    v_subrev_u32 v55, 7, v28
    v_cvt_f32_u32 v63, v55
    v_cvt_pk_bf16_f32 v56, v56, v57
    v_cvt_pk_bf16_f32 v58, v58, v59
    v_cvt_pk_bf16_f32 v60, v60, v61
    v_cvt_pk_bf16_f32 v62, v62, v63
    v_lshrrev_b32 v57, 16, v56
    v_and_b32 v56, s28, v56
    v_lshrrev_b32 v59, 16, v58
    v_and_b32 v58, s28, v58
    v_lshrrev_b32 v61, 16, v60
    v_and_b32 v60, s28, v60
    v_lshrrev_b32 v63, 16, v62
    v_and_b32 v62, s28, v62
    v_subrev_u32 v56, s29, v56
    v_subrev_u32 v57, s29, v57
    v_subrev_u32 v58, s29, v58
    v_subrev_u32 v59, s29, v59
    v_subrev_u32 v60, s29, v60
    v_subrev_u32 v61, s29, v61
    v_subrev_u32 v62, s29, v62
    v_subrev_u32 v63, s29, v63
    v_min_u32 v48, 0x80, v48
    v_min_u32 v49, 0x80, v49
    v_min_u32 v50, 0x80, v50
    v_min_u32 v51, 0x80, v51
    v_min_u32 v52, 0x80, v52
    v_min_u32 v53, 0x80, v53
    v_min_u32 v54, 0x80, v54
    v_min_u32 v55, 0x80, v55
    v_max_i32 v56, v56, v48
    v_max_i32 v57, v57, v49
    v_max_i32 v58, v58, v50
    v_max_i32 v59, v59, v51
    v_max_i32 v60, v60, v52
    v_max_i32 v61, v61, v53
    v_max_i32 v62, v62, v54
    v_max_i32 v63, v63, v55
    v_lshlrev_b32 v56, 2, v56
    v_lshlrev_b32 v57, 2, v57
    v_lshlrev_b32 v58, 2, v58
    v_lshlrev_b32 v59, 2, v59
    v_lshlrev_b32 v60, 2, v60
    v_lshlrev_b32 v61, 2, v61
    v_lshlrev_b32 v62, 2, v62
    v_lshlrev_b32 v63, 2, v63
    v_and_b32 v9, 15, v2
    v_lshrrev_b32 v17, 4, v2
    s_lshl_b32 s26, s3, 3
    s_add_u32 s26, s26, 8
    s_cmp_eq_u32 s3, 0
    s_cselect_b32 s26, 0, s26
    v_add_u32 v18, s26, v9
    v_mul_u32_u24 v18, 528, v18
    v_lshl_add_u32 v18, v17, 4, v18
    v_lshlrev_b32 v19, s3, v9
    v_or_b32 v29, 8, v19
    v_ffbh_u32 v29, v29
    v_sub_u32 v29, 28, v29
    v_lshrrev_b32 v19, v29, v19
    v_lshl_add_u32 v19, v29, 3, v19
    v_mul_u32_u24 v19, 528, v19
    v_lshl_add_u32 v19, v17, 4, v19
    s_waitcnt vmcnt(0)
    v_lshlrev_b32 v10, 16, v10
    v_lshlrev_b32 v11, 16, v11
    v_lshlrev_b32 v12, 16, v12
    v_lshlrev_b32 v13, 16, v13
    v_lshlrev_b32 v14, 16, v14
    v_lshlrev_b32 v15, 16, v15
    v_lshlrev_b32 v16, 16, v16
    v_mul_f32 v16, 0x3fb8aa3b, v16
    v_exp_f32 v16, v16
    s_nop 0
    v_cvt_pk_bf16_f32 v16, v16, v16
    v_lshlrev_b32 v16, 16, v16
    v_mul_f32 v20, v16, v10
    v_mul_f32 v21, v16, v11
    v_mul_f32 v12, v16, v12
    v_mul_f32 v13, v16, v13
    v_mul_f32 v20, 0x3fb8aa3b, v20
    v_mul_f32 v21, s36, v21
    v_mul_f32 v20, s27, v20
    v_mul_f32 v21, s27, v21
    v_mul_f32 v22, v14, v12
    v_mul_f32 v23, v14, v13
    v_fract_f32 v21, v21
    v_exp_f32 v20, v20
    v_fma_f32 v22, -v15, v13, v22
    v_fma_f32 v23, v15, v12, v23
    v_cos_f32 v24, v21
    v_sin_f32 v25, v21
    v_mov_b32 v26, 1.0
    v_mov_b32 v27, 0
    v_mul_f32 v24, v20, v24
    v_mul_f32 v25, v20, v25
    s_cmp_ge_u32 s3, 2
    s_cbranch_scc0 L_kg_y
    v_mov_b32 v26, v22
    v_mov_b32 v27, v23
L_kg_y:
    v_pk_mul_f32 v[30:31], v[24:25], v[24:25] op_sel:[0,0] op_sel_hi:[1,0]
    v_pk_fma_f32 v[32:33], v[24:25], v[24:25], v[30:31] op_sel:[1,1,0] op_sel_hi:[0,1,1] neg_lo:[1,0,0]
    v_pk_mul_f32 v[30:31], v[32:33], v[32:33] op_sel:[0,0] op_sel_hi:[1,0]
    v_pk_fma_f32 v[34:35], v[32:33], v[32:33], v[30:31] op_sel:[1,1,0] op_sel_hi:[0,1,1] neg_lo:[1,0,0]
    v_pk_mul_f32 v[30:31], v[34:35], v[34:35] op_sel:[0,0] op_sel_hi:[1,0]
    v_pk_fma_f32 v[36:37], v[34:35], v[34:35], v[30:31] op_sel:[1,1,0] op_sel_hi:[0,1,1] neg_lo:[1,0,0]
    v_cvt_pk_bf16_f32 v40, v26, v27
    v_pk_mul_f32 v[30:31], v[26:27], v[24:25] op_sel:[0,0] op_sel_hi:[1,0]
    v_pk_fma_f32 v[26:27], v[26:27], v[24:25], v[30:31] op_sel:[1,1,0] op_sel_hi:[0,1,1] neg_lo:[1,0,0]
    v_cvt_pk_bf16_f32 v41, v26, v27
    v_pk_mul_f32 v[30:31], v[26:27], v[24:25] op_sel:[0,0] op_sel_hi:[1,0]
    v_pk_fma_f32 v[26:27], v[26:27], v[24:25], v[30:31] op_sel:[1,1,0] op_sel_hi:[0,1,1] neg_lo:[1,0,0]
    ds_write2_b32 v8, v40, v41 offset0:0 offset1:132
    v_add_u32 v8, 1056, v8
    v_cvt_pk_bf16_f32 v42, v26, v27
    v_pk_mul_f32 v[30:31], v[26:27], v[24:25] op_sel:[0,0] op_sel_hi:[1,0]
    v_pk_fma_f32 v[26:27], v[26:27], v[24:25], v[30:31] op_sel:[1,1,0] op_sel_hi:[0,1,1] neg_lo:[1,0,0]
    v_cvt_pk_bf16_f32 v43, v26, v27
    v_pk_mul_f32 v[30:31], v[26:27], v[24:25] op_sel:[0,0] op_sel_hi:[1,0]
    v_pk_fma_f32 v[26:27], v[26:27], v[24:25], v[30:31] op_sel:[1,1,0] op_sel_hi:[0,1,1] neg_lo:[1,0,0]
    ds_write2_b32 v8, v42, v43 offset0:0 offset1:132
    v_add_u32 v8, 1056, v8
    v_cvt_pk_bf16_f32 v40, v26, v27
    v_pk_mul_f32 v[30:31], v[26:27], v[24:25] op_sel:[0,0] op_sel_hi:[1,0]
    v_pk_fma_f32 v[26:27], v[26:27], v[24:25], v[30:31] op_sel:[1,1,0] op_sel_hi:[0,1,1] neg_lo:[1,0,0]
    v_cvt_pk_bf16_f32 v41, v26, v27
    v_pk_mul_f32 v[30:31], v[26:27], v[24:25] op_sel:[0,0] op_sel_hi:[1,0]
    v_pk_fma_f32 v[26:27], v[26:27], v[24:25], v[30:31] op_sel:[1,1,0] op_sel_hi:[0,1,1] neg_lo:[1,0,0]
    ds_write2_b32 v8, v40, v41 offset0:0 offset1:132
    v_add_u32 v8, 1056, v8
    v_cvt_pk_bf16_f32 v42, v26, v27
    v_pk_mul_f32 v[30:31], v[26:27], v[24:25] op_sel:[0,0] op_sel_hi:[1,0]
    v_pk_fma_f32 v[26:27], v[26:27], v[24:25], v[30:31] op_sel:[1,1,0] op_sel_hi:[0,1,1] neg_lo:[1,0,0]
    v_cvt_pk_bf16_f32 v43, v26, v27
    v_pk_mul_f32 v[30:31], v[26:27], v[24:25] op_sel:[0,0] op_sel_hi:[1,0]
    v_pk_fma_f32 v[26:27], v[26:27], v[24:25], v[30:31] op_sel:[1,1,0] op_sel_hi:[0,1,1] neg_lo:[1,0,0]
    ds_write2_b32 v8, v42, v43 offset0:0 offset1:132
    v_add_u32 v8, 1056, v8
    v_cvt_pk_bf16_f32 v40, v26, v27
    v_pk_mul_f32 v[30:31], v[26:27], v[24:25] op_sel:[0,0] op_sel_hi:[1,0]
    v_pk_fma_f32 v[26:27], v[26:27], v[24:25], v[30:31] op_sel:[1,1,0] op_sel_hi:[0,1,1] neg_lo:[1,0,0]
    v_cvt_pk_bf16_f32 v41, v26, v27
    v_pk_mul_f32 v[30:31], v[26:27], v[24:25] op_sel:[0,0] op_sel_hi:[1,0]
    v_pk_fma_f32 v[26:27], v[26:27], v[24:25], v[30:31] op_sel:[1,1,0] op_sel_hi:[0,1,1] neg_lo:[1,0,0]
    ds_write2_b32 v8, v40, v41 offset0:0 offset1:132
    v_add_u32 v8, 1056, v8
    v_cvt_pk_bf16_f32 v42, v26, v27
    v_pk_mul_f32 v[30:31], v[26:27], v[24:25] op_sel:[0,0] op_sel_hi:[1,0]
    v_pk_fma_f32 v[26:27], v[26:27], v[24:25], v[30:31] op_sel:[1,1,0] op_sel_hi:[0,1,1] neg_lo:[1,0,0]
    v_cvt_pk_bf16_f32 v43, v26, v27
    v_pk_mul_f32 v[30:31], v[26:27], v[24:25] op_sel:[0,0] op_sel_hi:[1,0]
    v_pk_fma_f32 v[26:27], v[26:27], v[24:25], v[30:31] op_sel:[1,1,0] op_sel_hi:[0,1,1] neg_lo:[1,0,0]
    ds_write2_b32 v8, v42, v43 offset0:0 offset1:132
    v_add_u32 v8, 1056, v8
    v_cvt_pk_bf16_f32 v40, v26, v27
    v_pk_mul_f32 v[30:31], v[26:27], v[24:25] op_sel:[0,0] op_sel_hi:[1,0]
    v_pk_fma_f32 v[26:27], v[26:27], v[24:25], v[30:31] op_sel:[1,1,0] op_sel_hi:[0,1,1] neg_lo:[1,0,0]
    v_cvt_pk_bf16_f32 v41, v26, v27
    v_pk_mul_f32 v[30:31], v[26:27], v[24:25] op_sel:[0,0] op_sel_hi:[1,0]
    v_pk_fma_f32 v[26:27], v[26:27], v[24:25], v[30:31] op_sel:[1,1,0] op_sel_hi:[0,1,1] neg_lo:[1,0,0]
    ds_write2_b32 v8, v40, v41 offset0:0 offset1:132
    v_add_u32 v8, 1056, v8
    v_cvt_pk_bf16_f32 v42, v26, v27
    v_pk_mul_f32 v[30:31], v[26:27], v[24:25] op_sel:[0,0] op_sel_hi:[1,0]
    v_pk_fma_f32 v[26:27], v[26:27], v[24:25], v[30:31] op_sel:[1,1,0] op_sel_hi:[0,1,1] neg_lo:[1,0,0]
    v_cvt_pk_bf16_f32 v43, v26, v27
    v_pk_mul_f32 v[30:31], v[26:27], v[24:25] op_sel:[0,0] op_sel_hi:[1,0]
    v_pk_fma_f32 v[26:27], v[26:27], v[24:25], v[30:31] op_sel:[1,1,0] op_sel_hi:[0,1,1] neg_lo:[1,0,0]
    ds_write2_b32 v8, v42, v43 offset0:0 offset1:132
    v_add_u32 v8, 1056, v8
    v_cvt_pk_bf16_f32 v40, v26, v27
    v_pk_mul_f32 v[30:31], v[26:27], v[32:33] op_sel:[0,0] op_sel_hi:[1,0]
    v_pk_fma_f32 v[26:27], v[26:27], v[32:33], v[30:31] op_sel:[1,1,0] op_sel_hi:[0,1,1] neg_lo:[1,0,0]
    v_cvt_pk_bf16_f32 v41, v26, v27
    v_pk_mul_f32 v[30:31], v[26:27], v[32:33] op_sel:[0,0] op_sel_hi:[1,0]
    v_pk_fma_f32 v[26:27], v[26:27], v[32:33], v[30:31] op_sel:[1,1,0] op_sel_hi:[0,1,1] neg_lo:[1,0,0]
    ds_write2_b32 v8, v40, v41 offset0:0 offset1:132
    v_add_u32 v8, 1056, v8
    v_cvt_pk_bf16_f32 v42, v26, v27
    v_pk_mul_f32 v[30:31], v[26:27], v[32:33] op_sel:[0,0] op_sel_hi:[1,0]
    v_pk_fma_f32 v[26:27], v[26:27], v[32:33], v[30:31] op_sel:[1,1,0] op_sel_hi:[0,1,1] neg_lo:[1,0,0]
    v_cvt_pk_bf16_f32 v43, v26, v27
    v_pk_mul_f32 v[30:31], v[26:27], v[32:33] op_sel:[0,0] op_sel_hi:[1,0]
    v_pk_fma_f32 v[26:27], v[26:27], v[32:33], v[30:31] op_sel:[1,1,0] op_sel_hi:[0,1,1] neg_lo:[1,0,0]
    ds_write2_b32 v8, v42, v43 offset0:0 offset1:132
    v_add_u32 v8, 1056, v8
    v_cvt_pk_bf16_f32 v40, v26, v27
    v_pk_mul_f32 v[30:31], v[26:27], v[32:33] op_sel:[0,0] op_sel_hi:[1,0]
    v_pk_fma_f32 v[26:27], v[26:27], v[32:33], v[30:31] op_sel:[1,1,0] op_sel_hi:[0,1,1] neg_lo:[1,0,0]
    v_cvt_pk_bf16_f32 v41, v26, v27
    v_pk_mul_f32 v[30:31], v[26:27], v[32:33] op_sel:[0,0] op_sel_hi:[1,0]
    v_pk_fma_f32 v[26:27], v[26:27], v[32:33], v[30:31] op_sel:[1,1,0] op_sel_hi:[0,1,1] neg_lo:[1,0,0]
    ds_write2_b32 v8, v40, v41 offset0:0 offset1:132
    v_add_u32 v8, 1056, v8
    v_cvt_pk_bf16_f32 v42, v26, v27
    v_pk_mul_f32 v[30:31], v[26:27], v[32:33] op_sel:[0,0] op_sel_hi:[1,0]
    v_pk_fma_f32 v[26:27], v[26:27], v[32:33], v[30:31] op_sel:[1,1,0] op_sel_hi:[0,1,1] neg_lo:[1,0,0]
    v_cvt_pk_bf16_f32 v43, v26, v27
    v_pk_mul_f32 v[30:31], v[26:27], v[32:33] op_sel:[0,0] op_sel_hi:[1,0]
    v_pk_fma_f32 v[26:27], v[26:27], v[32:33], v[30:31] op_sel:[1,1,0] op_sel_hi:[0,1,1] neg_lo:[1,0,0]
    ds_write2_b32 v8, v42, v43 offset0:0 offset1:132
    v_add_u32 v8, 1056, v8
    v_cvt_pk_bf16_f32 v40, v26, v27
    v_pk_mul_f32 v[30:31], v[26:27], v[34:35] op_sel:[0,0] op_sel_hi:[1,0]
    v_pk_fma_f32 v[26:27], v[26:27], v[34:35], v[30:31] op_sel:[1,1,0] op_sel_hi:[0,1,1] neg_lo:[1,0,0]
    v_cvt_pk_bf16_f32 v41, v26, v27
    v_pk_mul_f32 v[30:31], v[26:27], v[34:35] op_sel:[0,0] op_sel_hi:[1,0]
    v_pk_fma_f32 v[26:27], v[26:27], v[34:35], v[30:31] op_sel:[1,1,0] op_sel_hi:[0,1,1] neg_lo:[1,0,0]
    ds_write2_b32 v8, v40, v41 offset0:0 offset1:132
    v_add_u32 v8, 1056, v8
    v_cvt_pk_bf16_f32 v42, v26, v27
    v_pk_mul_f32 v[30:31], v[26:27], v[34:35] op_sel:[0,0] op_sel_hi:[1,0]
    v_pk_fma_f32 v[26:27], v[26:27], v[34:35], v[30:31] op_sel:[1,1,0] op_sel_hi:[0,1,1] neg_lo:[1,0,0]
    v_cvt_pk_bf16_f32 v43, v26, v27
    v_pk_mul_f32 v[30:31], v[26:27], v[34:35] op_sel:[0,0] op_sel_hi:[1,0]
    v_pk_fma_f32 v[26:27], v[26:27], v[34:35], v[30:31] op_sel:[1,1,0] op_sel_hi:[0,1,1] neg_lo:[1,0,0]
    ds_write2_b32 v8, v42, v43 offset0:0 offset1:132
    v_add_u32 v8, 1056, v8
    v_cvt_pk_bf16_f32 v40, v26, v27
    v_pk_mul_f32 v[30:31], v[26:27], v[34:35] op_sel:[0,0] op_sel_hi:[1,0]
    v_pk_fma_f32 v[26:27], v[26:27], v[34:35], v[30:31] op_sel:[1,1,0] op_sel_hi:[0,1,1] neg_lo:[1,0,0]
    v_cvt_pk_bf16_f32 v41, v26, v27
    v_pk_mul_f32 v[30:31], v[26:27], v[34:35] op_sel:[0,0] op_sel_hi:[1,0]
    v_pk_fma_f32 v[26:27], v[26:27], v[34:35], v[30:31] op_sel:[1,1,0] op_sel_hi:[0,1,1] neg_lo:[1,0,0]
    ds_write2_b32 v8, v40, v41 offset0:0 offset1:132
    v_add_u32 v8, 1056, v8
    v_cvt_pk_bf16_f32 v42, v26, v27
    v_pk_mul_f32 v[30:31], v[26:27], v[34:35] op_sel:[0,0] op_sel_hi:[1,0]
    v_pk_fma_f32 v[26:27], v[26:27], v[34:35], v[30:31] op_sel:[1,1,0] op_sel_hi:[0,1,1] neg_lo:[1,0,0]
    v_cvt_pk_bf16_f32 v43, v26, v27
    v_pk_mul_f32 v[30:31], v[26:27], v[34:35] op_sel:[0,0] op_sel_hi:[1,0]
    v_pk_fma_f32 v[26:27], v[26:27], v[34:35], v[30:31] op_sel:[1,1,0] op_sel_hi:[0,1,1] neg_lo:[1,0,0]
    ds_write2_b32 v8, v42, v43 offset0:0 offset1:132
    v_add_u32 v8, 1056, v8
    v_cvt_pk_bf16_f32 v40, v26, v27
    v_pk_mul_f32 v[30:31], v[26:27], v[36:37] op_sel:[0,0] op_sel_hi:[1,0]
    v_pk_fma_f32 v[26:27], v[26:27], v[36:37], v[30:31] op_sel:[1,1,0] op_sel_hi:[0,1,1] neg_lo:[1,0,0]
    v_cvt_pk_bf16_f32 v41, v26, v27
    v_pk_mul_f32 v[30:31], v[26:27], v[36:37] op_sel:[0,0] op_sel_hi:[1,0]
    v_pk_fma_f32 v[26:27], v[26:27], v[36:37], v[30:31] op_sel:[1,1,0] op_sel_hi:[0,1,1] neg_lo:[1,0,0]
    ds_write2_b32 v8, v40, v41 offset0:0 offset1:132
    v_add_u32 v8, 1056, v8
    v_cvt_pk_bf16_f32 v42, v26, v27
    v_pk_mul_f32 v[30:31], v[26:27], v[36:37] op_sel:[0,0] op_sel_hi:[1,0]
    v_pk_fma_f32 v[26:27], v[26:27], v[36:37], v[30:31] op_sel:[1,1,0] op_sel_hi:[0,1,1] neg_lo:[1,0,0]
    v_cvt_pk_bf16_f32 v43, v26, v27
    v_pk_mul_f32 v[30:31], v[26:27], v[36:37] op_sel:[0,0] op_sel_hi:[1,0]
    v_pk_fma_f32 v[26:27], v[26:27], v[36:37], v[30:31] op_sel:[1,1,0] op_sel_hi:[0,1,1] neg_lo:[1,0,0]
    ds_write2_b32 v8, v42, v43 offset0:0 offset1:132
    v_add_u32 v8, 1056, v8
    v_cvt_pk_bf16_f32 v40, v26, v27
    v_pk_mul_f32 v[30:31], v[26:27], v[36:37] op_sel:[0,0] op_sel_hi:[1,0]
    v_pk_fma_f32 v[26:27], v[26:27], v[36:37], v[30:31] op_sel:[1,1,0] op_sel_hi:[0,1,1] neg_lo:[1,0,0]
    v_cvt_pk_bf16_f32 v41, v26, v27
    v_pk_mul_f32 v[30:31], v[26:27], v[36:37] op_sel:[0,0] op_sel_hi:[1,0]
    v_pk_fma_f32 v[26:27], v[26:27], v[36:37], v[30:31] op_sel:[1,1,0] op_sel_hi:[0,1,1] neg_lo:[1,0,0]
    ds_write2_b32 v8, v40, v41 offset0:0 offset1:132
    v_add_u32 v8, 1056, v8
    v_cvt_pk_bf16_f32 v42, v26, v27
    v_pk_mul_f32 v[30:31], v[26:27], v[36:37] op_sel:[0,0] op_sel_hi:[1,0]
    v_pk_fma_f32 v[26:27], v[26:27], v[36:37], v[30:31] op_sel:[1,1,0] op_sel_hi:[0,1,1] neg_lo:[1,0,0]
    v_cvt_pk_bf16_f32 v43, v26, v27
    v_pk_mul_f32 v[30:31], v[26:27], v[36:37] op_sel:[0,0] op_sel_hi:[1,0]
    v_pk_fma_f32 v[26:27], v[26:27], v[36:37], v[30:31] op_sel:[1,1,0] op_sel_hi:[0,1,1] neg_lo:[1,0,0]
    ds_write2_b32 v8, v42, v43 offset0:0 offset1:132
    v_add_u32 v8, 1056, v8
    v_cvt_pk_bf16_f32 v40, v26, v27
    ds_write_b32 v8, v40
    s_waitcnt lgkmcnt(0)
    s_barrier
    ds_read_b128 v[64:67], v18 offset:0
    ds_read_b128 v[68:71], v19 offset:21648
    ds_read_b128 v[72:75], v18 offset:64
    ds_read_b128 v[76:79], v19 offset:21712
    ds_read_b128 v[80:83], v18 offset:128
    ds_read_b128 v[84:87], v19 offset:21776
    ds_read_b128 v[88:91], v18 offset:192
    ds_read_b128 v[92:95], v19 offset:21840
    ds_read_b128 v[96:99], v18 offset:256
    ds_read_b128 v[100:103], v19 offset:21904
    ds_read_b128 v[104:107], v18 offset:320
    ds_read_b128 v[108:111], v19 offset:21968
    ds_read_b128 v[112:115], v18 offset:384
    ds_read_b128 v[116:119], v19 offset:22032
    ds_read_b128 v[120:123], v18 offset:448
    ds_read_b128 v[124:127], v19 offset:22096
    s_lshl_b32 s26, s3, 7
    s_add_u32 s26, s26, 128
    s_cmp_eq_u32 s3, 0
    s_cselect_b32 s26, 0, s26
    s_mov_b32 s27, 128
    s_cselect_b32 s27, 256, s27
    s_cmp_eq_u32 s3, 3
    s_cselect_b32 s27, 129, s27
    v_lshl_add_u32 v13, v17, 6, v9
    v_add_u32 v15, s26, v13
    v_lshlrev_b32 v15, 2, v15
    s_waitcnt lgkmcnt(14)
    v_mfma_f32_16x16x32_bf16 v[44:47], v[64:67], v[68:71], 0
    s_waitcnt lgkmcnt(12)
    v_mfma_f32_16x16x32_bf16 v[44:47], v[72:75], v[76:79], v[44:47]
    s_waitcnt lgkmcnt(10)
    v_mfma_f32_16x16x32_bf16 v[44:47], v[80:83], v[84:87], v[44:47]
    s_waitcnt lgkmcnt(8)
    v_mfma_f32_16x16x32_bf16 v[44:47], v[88:91], v[92:95], v[44:47]
    s_waitcnt lgkmcnt(6)
    v_mfma_f32_16x16x32_bf16 v[44:47], v[96:99], v[100:103], v[44:47]
    s_waitcnt lgkmcnt(4)
    v_mfma_f32_16x16x32_bf16 v[44:47], v[104:107], v[108:111], v[44:47]
    s_waitcnt lgkmcnt(2)
    v_mfma_f32_16x16x32_bf16 v[44:47], v[112:115], v[116:119], v[44:47]
    s_waitcnt lgkmcnt(0)
    v_mfma_f32_16x16x32_bf16 v[44:47], v[120:123], v[124:127], v[44:47]
    s_lshl_b32 s22, s2, 12
    s_add_u32 s22, s22, 0x900000
    v_lshlrev_b32 v3, 4, v0
    s_nop 4
    v_add_u32 v14, 0, v13
    v_cmp_gt_u32 vcc, s27, v14
    s_and_saveexec_b64 s[30:31], vcc
    ds_write_b32 v15, v44 offset:43296
    s_mov_b64 exec, s[30:31]
    v_add_u32 v14, 16, v13
    v_cmp_gt_u32 vcc, s27, v14
    s_and_saveexec_b64 s[30:31], vcc
    ds_write_b32 v15, v45 offset:43360
    s_mov_b64 exec, s[30:31]
    v_add_u32 v14, 32, v13
    v_cmp_gt_u32 vcc, s27, v14
    s_and_saveexec_b64 s[30:31], vcc
    ds_write_b32 v15, v46 offset:43424
    s_mov_b64 exec, s[30:31]
    v_add_u32 v14, 48, v13
    v_cmp_gt_u32 vcc, s27, v14
    s_and_saveexec_b64 s[30:31], vcc
    ds_write_b32 v15, v47 offset:43488
    s_mov_b64 exec, s[30:31]
    s_waitcnt lgkmcnt(0)
    s_barrier
    ds_read_b32 v64, v56 offset:43296
    ds_read_b32 v65, v57 offset:43296
    ds_read_b32 v66, v58 offset:43296
    ds_read_b32 v67, v59 offset:43296
    ds_read_b32 v68, v60 offset:43296
    ds_read_b32 v69, v61 offset:43296
    ds_read_b32 v70, v62 offset:43296
    ds_read_b32 v71, v63 offset:43296
    s_waitcnt lgkmcnt(0)
    v_cvt_pk_bf16_f32 v8, v64, v65
    v_cvt_pk_bf16_f32 v9, v66, v67
    v_cvt_pk_bf16_f32 v10, v68, v69
    v_cvt_pk_bf16_f32 v11, v70, v71
    buffer_store_dwordx4 v[8:11], v3, s[8:11], s22 offen
    s_endpgm
L_k1_exit:
    s_endpgm
L_k1_prep:
    s_sub_u32 s2, s2, 512
    s_load_dwordx2 s[4:5], s[0:1], 0
    s_load_dwordx2 s[6:7], s[0:1], 112
    s_load_dwordx2 s[8:9], s[0:1], 136
    v_lshrrev_b32 v1, 6, v0
    v_and_b32 v2, 63, v0
    v_readfirstlane_b32 s3, v1
    v_lshlrev_b32 v3, 4, v2
    s_lshl_b32 s24, s2, 3
    s_lshl_b32 s25, s3, 1
    s_add_u32 s24, s24, s25
    s_lshl_b32 s25, s24, 10
    s_mov_b32 s27, 0xffff0000
    s_waitcnt lgkmcnt(0)
    s_mov_b32 s12, s4
    s_mov_b32 s13, s5
    s_mov_b32 s14, 0x200000
    s_mov_b32 s15, 0x00020000
    s_mov_b32 s16, s6
    s_mov_b32 s17, s7
    s_mov_b32 s18, 0x400
    s_mov_b32 s19, 0x00020000
    buffer_load_dwordx4 v[64:67], v3, s[12:15], s25 offen
    buffer_load_dwordx4 v[104:107], v3, s[12:15], s25 offen offset:1024
    buffer_load_dwordx4 v[12:15], v3, s[16:19], 0 offen
    s_lshr_b32 s40, s2, 3
    s_and_b32 s41, s2, 7
    s_lshl_b32 s42, s40, 16
    s_lshl_b32 s43, s41, 7
    s_add_u32 s42, s42, s43
    v_lshrrev_b32 v44, 3, v0
    v_and_b32 v45, 7, v0
    v_lshlrev_b32 v43, 10, v44
    v_lshl_add_u32 v43, v45, 4, v43
    buffer_load_dwordx4 v[32:35], v43, s[12:15], s42 offen
    s_add_u32 s43, s42, 32768
    buffer_load_dwordx4 v[36:39], v43, s[12:15], s43 offen
    v_mul_u32_u24 v40, 192, v44
    v_lshl_add_u32 v40, v45, 4, v40
    v_and_b32 v44, 15, v2
    v_lshrrev_b32 v41, 2, v44
    s_lshl_b32 s44, s3, 4
    v_add_u32 v41, s44, v41
    v_mul_u32_u24 v41, 192, v41
    v_and_b32 v44, 3, v44
    v_lshl_add_u32 v41, v44, 3, v41
    v_lshrrev_b32 v44, 4, v2
    v_lshl_add_u32 v41, v44, 5, v41
    v_lshlrev_b32 v42, 12, v2
    s_lshl_b32 s44, s41, 18
    s_lshl_b32 s45, s40, 7
    s_add_u32 s44, s44, s45
    s_lshl_b32 s45, s3, 5
    s_add_u32 s44, s44, s45
    s_add_u32 s44, s44, 0x200000
    s_mov_b32 s20, s8
    s_mov_b32 s21, s9
    s_mov_b32 s22, 0x10000000
    s_mov_b32 s23, 0x00020000
    s_mul_i32 s26, s3, 2176
    v_add_u32 v4, s26, v3
    v_and_b32 v5, 15, v2
    v_lshrrev_b32 v6, 2, v5
    v_mul_u32_u24 v6, 1088, v6
    v_and_b32 v5, 3, v5
    v_lshl_add_u32 v6, v5, 3, v6
    v_lshrrev_b32 v5, 4, v2
    v_lshl_add_u32 v6, v5, 5, v6
    s_lshl_b32 s26, s3, 8
    v_add_u32 v6, s26, v6
    v_lshrrev_b32 v7, 5, v2
    s_lshl_b32 s26, s3, 2
    v_add_u32 v7, s26, v7
    v_lshlrev_b32 v7, 17, v7
    v_and_b32 v5, 31, v2
    v_lshl_add_u32 v7, v5, 4, v7
    s_lshl_b32 s28, s2, 9
    s_add_u32 s29, s28, 262144
    v_mov_b32 v60, 0x3b000000
    v_mov_b32 v61, 0x3727c5ac
    s_lshl_b32 s30, s24, 2
    s_add_u32 s30, s30, 0x800000
    v_mov_b32 v8, 0
    s_waitcnt vmcnt(2)
    v_lshlrev_b32 v24, 16, v12
    v_and_b32 v25, s27, v12
    v_lshlrev_b32 v26, 16, v13
    v_and_b32 v27, s27, v13
    v_lshlrev_b32 v28, 16, v14
    v_and_b32 v29, s27, v14
    v_lshlrev_b32 v30, 16, v15
    v_and_b32 v31, s27, v15
    v_lshlrev_b32 v72, 16, v64
    v_lshlrev_b32 v112, 16, v104
    v_and_b32 v73, s27, v64
    v_and_b32 v113, s27, v104
    v_lshlrev_b32 v74, 16, v65
    v_lshlrev_b32 v114, 16, v105
    v_and_b32 v75, s27, v65
    v_and_b32 v115, s27, v105
    v_lshlrev_b32 v76, 16, v66
    v_lshlrev_b32 v116, 16, v106
    v_and_b32 v77, s27, v66
    v_and_b32 v117, s27, v106
    v_lshlrev_b32 v78, 16, v67
    v_lshlrev_b32 v118, 16, v107
    v_and_b32 v79, s27, v67
    v_and_b32 v119, s27, v107
    v_pk_mul_f32 v[80:81], v[72:73], v[24:25]
    v_pk_mul_f32 v[120:121], v[112:113], v[24:25]
    v_pk_mul_f32 v[82:83], v[74:75], v[26:27]
    v_pk_mul_f32 v[122:123], v[114:115], v[26:27]
    v_pk_mul_f32 v[84:85], v[76:77], v[28:29]
    v_pk_mul_f32 v[124:125], v[116:117], v[28:29]
    v_pk_mul_f32 v[86:87], v[78:79], v[30:31]
    v_pk_mul_f32 v[126:127], v[118:119], v[30:31]
    v_pk_add_f32 v[88:89], v[72:73], v[74:75]
    v_pk_add_f32 v[128:129], v[112:113], v[114:115]
    v_pk_add_f32 v[90:91], v[76:77], v[78:79]
    v_pk_add_f32 v[130:131], v[116:117], v[118:119]
    v_cvt_pk_bf16_f32 v92, v80, v81
    v_cvt_pk_bf16_f32 v132, v120, v121
    v_cvt_pk_bf16_f32 v93, v82, v83
    v_cvt_pk_bf16_f32 v133, v122, v123
    v_cvt_pk_bf16_f32 v94, v84, v85
    v_cvt_pk_bf16_f32 v134, v124, v125
    v_cvt_pk_bf16_f32 v95, v86, v87
    v_cvt_pk_bf16_f32 v135, v126, v127
    v_pk_add_f32 v[88:89], v[88:89], v[90:91]
    v_pk_add_f32 v[128:129], v[128:129], v[130:131]
    v_lshlrev_b32 v80, 16, v92
    v_lshlrev_b32 v120, 16, v132
    v_and_b32 v81, s27, v92
    v_and_b32 v121, s27, v132
    v_lshlrev_b32 v82, 16, v93
    v_lshlrev_b32 v122, 16, v133
    v_and_b32 v83, s27, v93
    v_and_b32 v123, s27, v133
    v_lshlrev_b32 v84, 16, v94
    v_lshlrev_b32 v124, 16, v134
    v_and_b32 v85, s27, v94
    v_and_b32 v125, s27, v134
    v_lshlrev_b32 v86, 16, v95
    v_lshlrev_b32 v126, 16, v135
    v_and_b32 v87, s27, v95
    v_and_b32 v127, s27, v135
    v_add_f32 v88, v88, v89
    v_add_f32 v128, v128, v129
    v_pk_add_f32 v[90:91], v[80:81], v[82:83]
    v_pk_add_f32 v[130:131], v[120:121], v[122:123]
    v_pk_add_f32 v[92:93], v[84:85], v[86:87]
    v_pk_add_f32 v[132:133], v[124:125], v[126:127]
    v_pk_add_f32 v[90:91], v[90:91], v[92:93]
    v_pk_add_f32 v[130:131], v[130:131], v[132:133]
    v_add_f32 v89, v90, v91
    v_add_f32 v129, v130, v131
    v_add_f32_dpp v88, v88, v88 quad_perm:[1,0,3,2] row_mask:0xf bank_mask:0xf
    v_add_f32_dpp v128, v128, v128 quad_perm:[1,0,3,2] row_mask:0xf bank_mask:0xf
    v_add_f32_dpp v89, v89, v89 quad_perm:[1,0,3,2] row_mask:0xf bank_mask:0xf
    v_add_f32_dpp v129, v129, v129 quad_perm:[1,0,3,2] row_mask:0xf bank_mask:0xf
    v_add_f32_dpp v88, v88, v88 quad_perm:[2,3,0,1] row_mask:0xf bank_mask:0xf
    v_add_f32_dpp v128, v128, v128 quad_perm:[2,3,0,1] row_mask:0xf bank_mask:0xf
    v_add_f32_dpp v89, v89, v89 quad_perm:[2,3,0,1] row_mask:0xf bank_mask:0xf
    v_add_f32_dpp v129, v129, v129 quad_perm:[2,3,0,1] row_mask:0xf bank_mask:0xf
    v_add_f32_dpp v88, v88, v88 row_half_mirror row_mask:0xf bank_mask:0xf
    v_add_f32_dpp v128, v128, v128 row_half_mirror row_mask:0xf bank_mask:0xf
    v_add_f32_dpp v89, v89, v89 row_half_mirror row_mask:0xf bank_mask:0xf
    v_add_f32_dpp v129, v129, v129 row_half_mirror row_mask:0xf bank_mask:0xf
    v_add_f32_dpp v88, v88, v88 row_mirror row_mask:0xf bank_mask:0xf
    v_add_f32_dpp v128, v128, v128 row_mirror row_mask:0xf bank_mask:0xf
    v_add_f32_dpp v89, v89, v89 row_mirror row_mask:0xf bank_mask:0xf
    v_add_f32_dpp v129, v129, v129 row_mirror row_mask:0xf bank_mask:0xf
    v_add_f32_dpp v88, v88, v88 row_bcast:15 row_mask:0xa bank_mask:0xf
    v_add_f32_dpp v128, v128, v128 row_bcast:15 row_mask:0xa bank_mask:0xf
    v_add_f32_dpp v89, v89, v89 row_bcast:15 row_mask:0xa bank_mask:0xf
    v_add_f32_dpp v129, v129, v129 row_bcast:15 row_mask:0xa bank_mask:0xf
    v_add_f32_dpp v88, v88, v88 row_bcast:31 row_mask:0xc bank_mask:0xf
    v_add_f32_dpp v128, v128, v128 row_bcast:31 row_mask:0xc bank_mask:0xf
    v_add_f32_dpp v89, v89, v89 row_bcast:31 row_mask:0xc bank_mask:0xf
    v_add_f32_dpp v129, v129, v129 row_bcast:31 row_mask:0xc bank_mask:0xf
    v_readlane_b32 s32, v88, 63
    v_readlane_b32 s36, v128, 63
    v_readlane_b32 s33, v89, 63
    v_readlane_b32 s37, v129, 63
    s_nop 0
    v_mul_f32 v90, s32, v60
    v_mul_f32 v130, s36, v60
    v_mul_f32 v91, s32, v60
    v_mul_f32 v131, s36, v60
    v_mov_b32 v98, s33
    v_mov_b32 v138, s37
    v_pk_add_f32 v[80:81], v[72:73], v[90:91] neg_lo:[0,1] neg_hi:[0,1]
    v_pk_add_f32 v[120:121], v[112:113], v[130:131] neg_lo:[0,1] neg_hi:[0,1]
    v_pk_add_f32 v[82:83], v[74:75], v[90:91] neg_lo:[0,1] neg_hi:[0,1]
    v_pk_add_f32 v[122:123], v[114:115], v[130:131] neg_lo:[0,1] neg_hi:[0,1]
    v_pk_add_f32 v[84:85], v[76:77], v[90:91] neg_lo:[0,1] neg_hi:[0,1]
    v_pk_add_f32 v[124:125], v[116:117], v[130:131] neg_lo:[0,1] neg_hi:[0,1]
    v_pk_add_f32 v[86:87], v[78:79], v[90:91] neg_lo:[0,1] neg_hi:[0,1]
    v_pk_add_f32 v[126:127], v[118:119], v[130:131] neg_lo:[0,1] neg_hi:[0,1]
    v_pk_mul_f32 v[92:93], v[80:81], v[80:81]
    v_pk_mul_f32 v[132:133], v[120:121], v[120:121]
    v_pk_mul_f32 v[94:95], v[82:83], v[82:83]
    v_pk_mul_f32 v[134:135], v[122:123], v[122:123]
    v_pk_fma_f32 v[92:93], v[84:85], v[84:85], v[92:93]
    v_pk_fma_f32 v[132:133], v[124:125], v[124:125], v[132:133]
    v_pk_fma_f32 v[94:95], v[86:87], v[86:87], v[94:95]
    v_pk_fma_f32 v[134:135], v[126:127], v[126:127], v[134:135]
    v_cvt_pk_bf16_f32 v98, v98, v98
    v_cvt_pk_bf16_f32 v138, v138, v138
    v_lshlrev_b32 v98, 16, v98
    v_lshlrev_b32 v138, 16, v138
    v_pk_add_f32 v[92:93], v[92:93], v[94:95]
    v_pk_add_f32 v[132:133], v[132:133], v[134:135]
    v_mul_f32 v98, 0xbfb8aa3b, v98
    v_mul_f32 v138, 0xbfb8aa3b, v138
    v_add_f32 v92, v92, v93
    v_add_f32 v132, v132, v133
    v_exp_f32 v98, v98
    v_exp_f32 v138, v138
    v_cvt_pk_bf16_f32 v90, v90, v90
    v_cvt_pk_bf16_f32 v130, v130, v130
    v_lshlrev_b32 v90, 16, v90
    v_lshlrev_b32 v130, 16, v130
    v_add_f32_dpp v92, v92, v92 quad_perm:[1,0,3,2] row_mask:0xf bank_mask:0xf
    v_add_f32_dpp v132, v132, v132 quad_perm:[1,0,3,2] row_mask:0xf bank_mask:0xf
    v_add_f32 v98, 1.0, v98
    v_add_f32 v138, 1.0, v138
    v_mov_b32 v91, v90
    v_mov_b32 v131, v130
    v_add_f32_dpp v92, v92, v92 quad_perm:[2,3,0,1] row_mask:0xf bank_mask:0xf
    v_add_f32_dpp v132, v132, v132 quad_perm:[2,3,0,1] row_mask:0xf bank_mask:0xf
    v_rcp_f32 v98, v98
    v_rcp_f32 v138, v138
    v_add_f32_dpp v92, v92, v92 row_half_mirror row_mask:0xf bank_mask:0xf
    v_add_f32_dpp v132, v132, v132 row_half_mirror row_mask:0xf bank_mask:0xf
    s_nop 0
    v_add_f32_dpp v92, v92, v92 row_mirror row_mask:0xf bank_mask:0xf
    v_add_f32_dpp v132, v132, v132 row_mirror row_mask:0xf bank_mask:0xf
    s_nop 0
    v_add_f32_dpp v92, v92, v92 row_bcast:15 row_mask:0xa bank_mask:0xf
    v_add_f32_dpp v132, v132, v132 row_bcast:15 row_mask:0xa bank_mask:0xf
    s_nop 0
    v_add_f32_dpp v92, v92, v92 row_bcast:31 row_mask:0xc bank_mask:0xf
    v_add_f32_dpp v132, v132, v132 row_bcast:31 row_mask:0xc bank_mask:0xf
    s_nop 0
    v_readlane_b32 s34, v92, 63
    v_readlane_b32 s38, v132, 63
    v_pk_add_f32 v[72:73], v[72:73], v[90:91] neg_lo:[0,1] neg_hi:[0,1]
    v_pk_add_f32 v[112:113], v[112:113], v[130:131] neg_lo:[0,1] neg_hi:[0,1]
    v_pk_add_f32 v[74:75], v[74:75], v[90:91] neg_lo:[0,1] neg_hi:[0,1]
    v_pk_add_f32 v[114:115], v[114:115], v[130:131] neg_lo:[0,1] neg_hi:[0,1]
    v_pk_add_f32 v[76:77], v[76:77], v[90:91] neg_lo:[0,1] neg_hi:[0,1]
    v_pk_add_f32 v[116:117], v[116:117], v[130:131] neg_lo:[0,1] neg_hi:[0,1]
    v_pk_add_f32 v[78:79], v[78:79], v[90:91] neg_lo:[0,1] neg_hi:[0,1]
    v_pk_add_f32 v[118:119], v[118:119], v[130:131] neg_lo:[0,1] neg_hi:[0,1]
    v_mul_f32 v92, s34, v60
    v_mul_f32 v132, s38, v60
    v_cvt_pk_bf16_f32 v80, v72, v73
    v_cvt_pk_bf16_f32 v120, v112, v113
    v_cvt_pk_bf16_f32 v81, v74, v75
    v_cvt_pk_bf16_f32 v121, v114, v115
    v_cvt_pk_bf16_f32 v82, v76, v77
    v_cvt_pk_bf16_f32 v122, v116, v117
    v_cvt_pk_bf16_f32 v83, v78, v79
    v_cvt_pk_bf16_f32 v123, v118, v119
    v_cvt_pk_bf16_f32 v92, v92, v92
    v_cvt_pk_bf16_f32 v132, v132, v132
    v_lshlrev_b32 v92, 16, v92
    v_lshlrev_b32 v132, 16, v132
    v_cvt_pk_bf16_f32 v98, v98, v98
    v_cvt_pk_bf16_f32 v138, v138, v138
    v_lshlrev_b32 v98, 16, v98
    v_lshlrev_b32 v138, 16, v138
    v_add_f32 v92, v92, v61
    v_add_f32 v132, v132, v61
    v_lshlrev_b32 v72, 16, v80
    v_lshlrev_b32 v112, 16, v120
    v_and_b32 v73, s27, v80
    v_and_b32 v113, s27, v120
    v_lshlrev_b32 v74, 16, v81
    v_lshlrev_b32 v114, 16, v121
    v_and_b32 v75, s27, v81
    v_and_b32 v115, s27, v121
    v_lshlrev_b32 v76, 16, v82
    v_lshlrev_b32 v116, 16, v122
    v_and_b32 v77, s27, v82
    v_and_b32 v117, s27, v122
    v_lshlrev_b32 v78, 16, v83
    v_lshlrev_b32 v118, 16, v123
    v_and_b32 v79, s27, v83
    v_and_b32 v119, s27, v123
    v_cvt_pk_bf16_f32 v92, v92, v92
    v_cvt_pk_bf16_f32 v132, v132, v132
    v_lshlrev_b32 v92, 16, v92
    v_lshlrev_b32 v132, 16, v132
    v_sqrt_f32 v92, v92
    v_sqrt_f32 v132, v132
    v_cvt_pk_bf16_f32 v92, v92, v92
    v_cvt_pk_bf16_f32 v132, v132, v132
    v_lshlrev_b32 v92, 16, v92
    v_lshlrev_b32 v132, 16, v132
    v_rcp_f32 v92, v92
    v_rcp_f32 v132, v132
    v_mov_b32 v93, v92
    v_mov_b32 v133, v132
    v_pk_mul_f32 v[72:73], v[72:73], v[92:93]
    v_pk_mul_f32 v[112:113], v[112:113], v[132:133]
    v_pk_mul_f32 v[74:75], v[74:75], v[92:93]
    v_pk_mul_f32 v[114:115], v[114:115], v[132:133]
    v_pk_mul_f32 v[76:77], v[76:77], v[92:93]
    v_pk_mul_f32 v[116:117], v[116:117], v[132:133]
    v_pk_mul_f32 v[78:79], v[78:79], v[92:93]
    v_pk_mul_f32 v[118:119], v[118:119], v[132:133]
    v_cvt_pk_bf16_f32 v80, v72, v73
    v_cvt_pk_bf16_f32 v120, v112, v113
    v_cvt_pk_bf16_f32 v81, v74, v75
    v_cvt_pk_bf16_f32 v121, v114, v115
    v_cvt_pk_bf16_f32 v82, v76, v77
    v_cvt_pk_bf16_f32 v122, v116, v117
    v_cvt_pk_bf16_f32 v83, v78, v79
    v_cvt_pk_bf16_f32 v123, v118, v119
    s_waitcnt vmcnt(0)
    ds_write_b128 v40, v[32:35] offset:8704
    ds_write_b128 v40, v[36:39] offset:14848
    ds_write_b128 v4, v[80:83]
    ds_write_b128 v4, v[120:123] offset:1088
    s_lshl_b32 s31, s3, 3
    v_mov_b32 v9, s31
    s_mov_b64 exec, 1
    v_add_u32 v9, 20992, v9
    ds_write2_b32 v9, v98, v138 offset0:0 offset1:1
    s_mov_b64 exec, -1
    s_waitcnt lgkmcnt(0)
    s_barrier
    ds_read_b64_tr_b16 v[8:9], v6 offset:0
    ds_read_b64_tr_b16 v[10:11], v6 offset:4352
    ds_read_b64_tr_b16 v[12:13], v6 offset:128
    ds_read_b64_tr_b16 v[14:15], v6 offset:4480
    ds_read_b64_tr_b16 v[32:33], v41 offset:8704
    ds_read_b64_tr_b16 v[34:35], v41 offset:9472
    ds_read_b64_tr_b16 v[36:37], v41 offset:10240
    ds_read_b64_tr_b16 v[38:39], v41 offset:11008
    s_waitcnt lgkmcnt(6)
    buffer_store_dwordx4 v[8:11], v7, s[20:23], s28 offen
    s_waitcnt lgkmcnt(4)
    buffer_store_dwordx4 v[12:15], v7, s[20:23], s29 offen
    v_mul_u32_u24 v42, 144, v2
    s_lshl_b32 s45, s3, 5
    v_add_u32 v42, s45, v42
    s_waitcnt lgkmcnt(0)
    ds_write_b128 v42, v[32:35] offset:21056
    ds_write_b128 v42, v[36:39] offset:21072
    v_lshrrev_b32 v44, 3, v0
    v_and_b32 v45, 7, v0
    v_mul_u32_u24 v42, 144, v44
    v_lshl_add_u32 v42, v45, 4, v42
    v_lshlrev_b32 v43, 12, v44
    v_lshl_add_u32 v43, v45, 4, v43
    s_lshl_b32 s44, s41, 18
    s_lshl_b32 s45, s40, 7
    s_add_u32 s44, s44, s45
    s_add_u32 s44, s44, 0x200000
    s_add_u32 s45, s44, 131072
    v_lshlrev_b32 v9, 2, v2
    s_lshl_b32 s30, s2, 5
    s_add_u32 s30, s30, 0x800000
    s_waitcnt lgkmcnt(0)
    s_barrier
    ds_read_b128 v[32:35], v42 offset:21056
    ds_read_b128 v[36:39], v42 offset:25664
    ds_read_b32 v10, v9 offset:20992
    s_waitcnt lgkmcnt(2)
    buffer_store_dwordx4 v[32:35], v43, s[20:23], s44 offen
    s_waitcnt lgkmcnt(1)
    buffer_store_dwordx4 v[36:39], v43, s[20:23], s45 offen
    s_waitcnt lgkmcnt(0)
    s_cmp_lg_u32 s3, 0
    s_cbranch_scc1 L_prep_nog
    s_mov_b64 exec, 0xff
    buffer_store_dword v10, v9, s[20:23], s30 offen
    s_mov_b64 exec, -1
L_prep_nog:
    s_endpgm
.globl k2_gemm1_conv_kernel
.p2align 8
.type k2_gemm1_conv_kernel,@function
k2_gemm1_conv_kernel:
    s_cmp_ge_u32 s2, 736
    s_cbranch_scc1 L_k2_exit
    s_cmp_lt_u32 s2, 512
    s_cbranch_scc1 L_k2_conv
    s_sub_u32 s2, s2, 512
    s_setprio 3
    s_load_dwordx2 s[4:5], s[0:1], 80
    s_load_dwordx2 s[6:7], s[0:1], 136
    s_load_dwordx2 s[36:37], s[0:1], 88
    v_lshrrev_b32 v1, 6, v0
    v_and_b32 v2, 63, v0
    v_readfirstlane_b32 s3, v1
    s_and_b32 s20, s2, 7
    s_lshr_b32 s21, s2, 3
    s_mul_i32 s20, s20, 28
    s_add_u32 s20, s20, s21
    s_lshr_b32 s21, s20, 3
    s_and_b32 s22, s20, 7
    s_mul_i32 s23, s22, 262144
    s_mul_i32 s24, s3, 32768
    s_add_u32 s23, s23, s24
    s_add_u32 s23, s23, 0x0
    v_lshlrev_b32 v3, 4, v2
    v_add_u32 v4, 131072, v3
    v_lshrrev_b32 v5, 3, v2
    v_and_b32 v6, 7, v2
    v_lshlrev_b32 v7, 1, v5
    v_and_b32 v7, 4, v7
    v_xor_b32 v6, v6, v7
    v_mul_u32_u24 v5, 3584, v5
    v_lshl_add_u32 v5, v6, 4, v5
    s_lshl_b32 s24, s21, 7
    v_add_u32 v5, s24, v5
    s_mul_i32 s25, s3, 1835008
    s_mul_i32 s26, s3, 12288
    s_waitcnt lgkmcnt(0)
    s_mov_b32 s8, s4
    s_mov_b32 s9, s5
    s_mov_b32 s10, 0x700000
    s_mov_b32 s11, 0x00020000
    s_mov_b32 s12, s6
    s_mov_b32 s13, s7
    s_mov_b32 s14, 0x10000000
    s_mov_b32 s15, 0x00020000
    s_and_b32 s48, s21, 3
    s_lshl2_add_u32 s48, s22, s48
    s_sub_u32 s49, s48, 32
    s_cmp_ge_u32 s48, 32
    s_cselect_b32 s48, s49, s48
    s_mul_i32 s27, s48, 57344
    s_add_u32 m0, s26, 0
    s_add_u32 s27, s27, s25
    buffer_load_dwordx4 v5, s[8:11], s27 offen lds
    s_add_u32 m0, s26, 1024
    s_add_u32 s27, s27, 28672
    s_lshl_b32 s28, s48, 10
    buffer_load_dwordx4 v5, s[8:11], s27 offen lds
    s_add_u32 s28, s28, s23
    s_add_u32 s48, s48, 1
    buffer_load_dwordx4 v[80:83], v3, s[12:15], s28 offen
    buffer_load_dwordx4 v[84:87], v4, s[12:15], s28 offen
    s_cmp_lg_u32 s48, 32
    s_cselect_b32 s48, s48, 0
    s_mul_i32 s27, s48, 57344
    s_add_u32 m0, s26, 2048
    s_add_u32 s27, s27, s25
    buffer_load_dwordx4 v5, s[8:11], s27 offen lds
    s_add_u32 m0, s26, 3072
    s_add_u32 s27, s27, 28672
    s_lshl_b32 s28, s48, 10
    buffer_load_dwordx4 v5, s[8:11], s27 offen lds
    s_add_u32 s28, s28, s23
    s_add_u32 s48, s48, 1
    buffer_load_dwordx4 v[88:91], v3, s[12:15], s28 offen
    buffer_load_dwordx4 v[92:95], v4, s[12:15], s28 offen
    s_cmp_lg_u32 s48, 32
    s_cselect_b32 s48, s48, 0
    s_mov_b32 s40, s36
    s_mov_b32 s41, s37
    s_mov_b32 s42, 0xe00
    s_mov_b32 s43, 0x00020000
    s_mul_i32 s27, s48, 57344
    s_add_u32 m0, s26, 4096
    s_add_u32 s27, s27, s25
    buffer_load_dwordx4 v5, s[8:11], s27 offen lds
    s_add_u32 m0, s26, 5120
    s_add_u32 s27, s27, 28672
    s_lshl_b32 s28, s48, 10
    buffer_load_dwordx4 v5, s[8:11], s27 offen lds
    s_add_u32 s28, s28, s23
    s_add_u32 s48, s48, 1
    buffer_load_dwordx4 v[96:99], v3, s[12:15], s28 offen
    buffer_load_dwordx4 v[100:103], v4, s[12:15], s28 offen
    s_cmp_lg_u32 s48, 32
    s_cselect_b32 s48, s48, 0
    s_mul_i32 s27, s48, 57344
    s_add_u32 m0, s26, 6144
    s_add_u32 s27, s27, s25
    buffer_load_dwordx4 v5, s[8:11], s27 offen lds
    s_add_u32 m0, s26, 7168
    s_add_u32 s27, s27, 28672
    s_lshl_b32 s28, s48, 10
    buffer_load_dwordx4 v5, s[8:11], s27 offen lds
    s_add_u32 s28, s28, s23
    s_add_u32 s48, s48, 1
    buffer_load_dwordx4 v[104:107], v3, s[12:15], s28 offen
    buffer_load_dwordx4 v[108:111], v4, s[12:15], s28 offen
    s_cmp_lg_u32 s48, 32
    s_cselect_b32 s48, s48, 0
    s_mul_i32 s27, s48, 57344
    s_add_u32 m0, s26, 8192
    s_add_u32 s27, s27, s25
    buffer_load_dwordx4 v5, s[8:11], s27 offen lds
    s_add_u32 m0, s26, 9216
    s_add_u32 s27, s27, 28672
    s_lshl_b32 s28, s48, 10
    buffer_load_dwordx4 v5, s[8:11], s27 offen lds
    s_add_u32 s28, s28, s23
    s_add_u32 s48, s48, 1
    buffer_load_dwordx4 v[112:115], v3, s[12:15], s28 offen
    buffer_load_dwordx4 v[116:119], v4, s[12:15], s28 offen
    s_cmp_lg_u32 s48, 32
    s_cselect_b32 s48, s48, 0
    s_mul_i32 s27, s48, 57344
    s_add_u32 m0, s26, 10240
    s_add_u32 s27, s27, s25
    buffer_load_dwordx4 v5, s[8:11], s27 offen lds
    s_add_u32 m0, s26, 11264
    s_add_u32 s27, s27, 28672
    s_lshl_b32 s28, s48, 10
    buffer_load_dwordx4 v5, s[8:11], s27 offen lds
    s_add_u32 s28, s28, s23
    s_add_u32 s48, s48, 1
    buffer_load_dwordx4 v[120:123], v3, s[12:15], s28 offen
    buffer_load_dwordx4 v[124:127], v4, s[12:15], s28 offen
    s_cmp_lg_u32 s48, 32
    s_cselect_b32 s48, s48, 0
    v_lshrrev_b32 v8, 4, v2
    v_and_b32 v9, 15, v2
    v_lshrrev_b32 v10, 2, v9
    v_and_b32 v11, 3, v9
    v_lshrrev_b32 v12, 1, v8
    v_lshl_add_u32 v12, v12, 3, v10
    v_lshlrev_b32 v12, 7, v12
    v_and_b32 v13, 1, v8
    v_lshlrev_b32 v13, 1, v13
    v_lshrrev_b32 v14, 1, v11
    v_add_u32 v13, v13, v14
    v_lshlrev_b32 v14, 1, v10
    v_and_b32 v14, 4, v14
    v_xor_b32 v13, v13, v14
    v_lshl_add_u32 v12, v13, 4, v12
    v_and_b32 v14, 1, v11
    v_lshl_add_u32 v12, v14, 3, v12
    v_add_u32 v12, s26, v12
    v_xor_b32 v13, 64, v12
    s_lshr_b32 s29, s3, 1
    s_and_b32 s30, s3, 1
    v_and_b32 v6, 31, v2
    v_lshrrev_b32 v7, 5, v2
    s_lshl_b32 s31, s21, 7
    s_lshl_b32 s32, s29, 6
    s_add_u32 s31, s31, s32
    v_lshlrev_b32 v14, 3, v7
    buffer_load_dwordx2 v[144:145], v14, s[40:43], s31 offen offset:0
    buffer_load_dwordx2 v[146:147], v14, s[40:43], s31 offen offset:16
    buffer_load_dwordx2 v[148:149], v14, s[40:43], s31 offen offset:32
    buffer_load_dwordx2 v[150:151], v14, s[40:43], s31 offen offset:48
    v_mov_b32 v16, 0
    v_mov_b32 v17, 0
    v_mov_b32 v18, 0
    v_mov_b32 v19, 0
    v_mov_b32 v20, 0
    v_mov_b32 v21, 0
    v_mov_b32 v22, 0
    v_mov_b32 v23, 0
    v_mov_b32 v24, 0
    v_mov_b32 v25, 0
    v_mov_b32 v26, 0
    v_mov_b32 v27, 0
    v_mov_b32 v28, 0
    v_mov_b32 v29, 0
    v_mov_b32 v30, 0
    v_mov_b32 v31, 0
    v_mov_b32 v32, 0
    v_mov_b32 v33, 0
    v_mov_b32 v34, 0
    v_mov_b32 v35, 0
    v_mov_b32 v36, 0
    v_mov_b32 v37, 0
    v_mov_b32 v38, 0
    v_mov_b32 v39, 0
    v_mov_b32 v40, 0
    v_mov_b32 v41, 0
    v_mov_b32 v42, 0
    v_mov_b32 v43, 0
    v_mov_b32 v44, 0
    v_mov_b32 v45, 0
    v_mov_b32 v46, 0
    v_mov_b32 v47, 0
    v_mov_b32 v48, 0
    v_mov_b32 v49, 0
    v_mov_b32 v50, 0
    v_mov_b32 v51, 0
    v_mov_b32 v52, 0
    v_mov_b32 v53, 0
    v_mov_b32 v54, 0
    v_mov_b32 v55, 0
    v_mov_b32 v56, 0
    v_mov_b32 v57, 0
    v_mov_b32 v58, 0
    v_mov_b32 v59, 0
    v_mov_b32 v60, 0
    v_mov_b32 v61, 0
    v_mov_b32 v62, 0
    v_mov_b32 v63, 0
    v_mov_b32 v64, 0
    v_mov_b32 v65, 0
    v_mov_b32 v66, 0
    v_mov_b32 v67, 0
    v_mov_b32 v68, 0
    v_mov_b32 v69, 0
    v_mov_b32 v70, 0
    v_mov_b32 v71, 0
    v_mov_b32 v72, 0
    v_mov_b32 v73, 0
    v_mov_b32 v74, 0
    v_mov_b32 v75, 0
    v_mov_b32 v76, 0
    v_mov_b32 v77, 0
    v_mov_b32 v78, 0
    v_mov_b32 v79, 0
    s_mov_b32 s50, 4
    s_waitcnt vmcnt(24)
    ds_read_b64_tr_b16 v[128:129], v12 offset:0
    ds_read_b64_tr_b16 v[130:131], v12 offset:512
    ds_read_b64_tr_b16 v[132:133], v13 offset:0
    ds_read_b64_tr_b16 v[134:135], v13 offset:512
L_g1_loop:
    s_waitcnt vmcnt(16)
    ds_read_b64_tr_b16 v[136:137], v12 offset:2048
    ds_read_b64_tr_b16 v[138:139], v12 offset:2560
    ds_read_b64_tr_b16 v[140:141], v13 offset:2048
    ds_read_b64_tr_b16 v[142:143], v13 offset:2560
    s_waitcnt lgkmcnt(4)
    v_mfma_f32_32x32x16_bf16 v[16:31], v[128:131], v[80:83], v[16:31]
    v_mfma_f32_32x32x16_bf16 v[32:47], v[128:131], v[84:87], v[32:47]
    v_mfma_f32_32x32x16_bf16 v[48:63], v[132:135], v[80:83], v[48:63]
    v_mfma_f32_32x32x16_bf16 v[64:79], v[132:135], v[84:87], v[64:79]
    s_mul_i32 s27, s48, 57344
    s_add_u32 m0, s26, 0
    s_add_u32 s27, s27, s25
    buffer_load_dwordx4 v5, s[8:11], s27 offen lds
    s_add_u32 m0, s26, 1024
    s_add_u32 s27, s27, 28672
    s_lshl_b32 s28, s48, 10
    buffer_load_dwordx4 v5, s[8:11], s27 offen lds
    s_add_u32 s28, s28, s23
    s_add_u32 s48, s48, 1
    buffer_load_dwordx4 v[80:83], v3, s[12:15], s28 offen
    buffer_load_dwordx4 v[84:87], v4, s[12:15], s28 offen
    s_cmp_lg_u32 s48, 32
    s_cselect_b32 s48, s48, 0
    s_waitcnt vmcnt(16)
    ds_read_b64_tr_b16 v[128:129], v12 offset:4096
    ds_read_b64_tr_b16 v[130:131], v12 offset:4608
    ds_read_b64_tr_b16 v[132:133], v13 offset:4096
    ds_read_b64_tr_b16 v[134:135], v13 offset:4608
    s_waitcnt lgkmcnt(4)
    v_mfma_f32_32x32x16_bf16 v[16:31], v[136:139], v[88:91], v[16:31]
    v_mfma_f32_32x32x16_bf16 v[32:47], v[136:139], v[92:95], v[32:47]
    v_mfma_f32_32x32x16_bf16 v[48:63], v[140:143], v[88:91], v[48:63]
    v_mfma_f32_32x32x16_bf16 v[64:79], v[140:143], v[92:95], v[64:79]
    s_mul_i32 s27, s48, 57344
    s_add_u32 m0, s26, 2048
    s_add_u32 s27, s27, s25
    buffer_load_dwordx4 v5, s[8:11], s27 offen lds
    s_add_u32 m0, s26, 3072
    s_add_u32 s27, s27, 28672
    s_lshl_b32 s28, s48, 10
    buffer_load_dwordx4 v5, s[8:11], s27 offen lds
    s_add_u32 s28, s28, s23
    s_add_u32 s48, s48, 1
    buffer_load_dwordx4 v[88:91], v3, s[12:15], s28 offen
    buffer_load_dwordx4 v[92:95], v4, s[12:15], s28 offen
    s_cmp_lg_u32 s48, 32
    s_cselect_b32 s48, s48, 0
    s_waitcnt vmcnt(16)
    ds_read_b64_tr_b16 v[136:137], v12 offset:6144
    ds_read_b64_tr_b16 v[138:139], v12 offset:6656
    ds_read_b64_tr_b16 v[140:141], v13 offset:6144
    ds_read_b64_tr_b16 v[142:143], v13 offset:6656
    s_waitcnt lgkmcnt(4)
    v_mfma_f32_32x32x16_bf16 v[16:31], v[128:131], v[96:99], v[16:31]
    v_mfma_f32_32x32x16_bf16 v[32:47], v[128:131], v[100:103], v[32:47]
    v_mfma_f32_32x32x16_bf16 v[48:63], v[132:135], v[96:99], v[48:63]
    v_mfma_f32_32x32x16_bf16 v[64:79], v[132:135], v[100:103], v[64:79]
    s_mul_i32 s27, s48, 57344
    s_add_u32 m0, s26, 4096
    s_add_u32 s27, s27, s25
    buffer_load_dwordx4 v5, s[8:11], s27 offen lds
    s_add_u32 m0, s26, 5120
    s_add_u32 s27, s27, 28672
    s_lshl_b32 s28, s48, 10
    buffer_load_dwordx4 v5, s[8:11], s27 offen lds
    s_add_u32 s28, s28, s23
    s_add_u32 s48, s48, 1
    buffer_load_dwordx4 v[96:99], v3, s[12:15], s28 offen
    buffer_load_dwordx4 v[100:103], v4, s[12:15], s28 offen
    s_cmp_lg_u32 s48, 32
    s_cselect_b32 s48, s48, 0
    s_waitcnt vmcnt(16)
    ds_read_b64_tr_b16 v[128:129], v12 offset:8192
    ds_read_b64_tr_b16 v[130:131], v12 offset:8704
    ds_read_b64_tr_b16 v[132:133], v13 offset:8192
    ds_read_b64_tr_b16 v[134:135], v13 offset:8704
    s_waitcnt lgkmcnt(4)
    v_mfma_f32_32x32x16_bf16 v[16:31], v[136:139], v[104:107], v[16:31]
    v_mfma_f32_32x32x16_bf16 v[32:47], v[136:139], v[108:111], v[32:47]
    v_mfma_f32_32x32x16_bf16 v[48:63], v[140:143], v[104:107], v[48:63]
    v_mfma_f32_32x32x16_bf16 v[64:79], v[140:143], v[108:111], v[64:79]
    s_mul_i32 s27, s48, 57344
    s_add_u32 m0, s26, 6144
    s_add_u32 s27, s27, s25
    buffer_load_dwordx4 v5, s[8:11], s27 offen lds
    s_add_u32 m0, s26, 7168
    s_add_u32 s27, s27, 28672
    s_lshl_b32 s28, s48, 10
    buffer_load_dwordx4 v5, s[8:11], s27 offen lds
    s_add_u32 s28, s28, s23
    s_add_u32 s48, s48, 1
    buffer_load_dwordx4 v[104:107], v3, s[12:15], s28 offen
    buffer_load_dwordx4 v[108:111], v4, s[12:15], s28 offen
    s_cmp_lg_u32 s48, 32
    s_cselect_b32 s48, s48, 0
    s_waitcnt vmcnt(16)
    ds_read_b64_tr_b16 v[136:137], v12 offset:10240
    ds_read_b64_tr_b16 v[138:139], v12 offset:10752
    ds_read_b64_tr_b16 v[140:141], v13 offset:10240
    ds_read_b64_tr_b16 v[142:143], v13 offset:10752
    s_waitcnt lgkmcnt(4)
    v_mfma_f32_32x32x16_bf16 v[16:31], v[128:131], v[112:115], v[16:31]
    v_mfma_f32_32x32x16_bf16 v[32:47], v[128:131], v[116:119], v[32:47]
    v_mfma_f32_32x32x16_bf16 v[48:63], v[132:135], v[112:115], v[48:63]
    v_mfma_f32_32x32x16_bf16 v[64:79], v[132:135], v[116:119], v[64:79]
    s_mul_i32 s27, s48, 57344
    s_add_u32 m0, s26, 8192
    s_add_u32 s27, s27, s25
    buffer_load_dwordx4 v5, s[8:11], s27 offen lds
    s_add_u32 m0, s26, 9216
    s_add_u32 s27, s27, 28672
    s_lshl_b32 s28, s48, 10
    buffer_load_dwordx4 v5, s[8:11], s27 offen lds
    s_add_u32 s28, s28, s23
    s_add_u32 s48, s48, 1
    buffer_load_dwordx4 v[112:115], v3, s[12:15], s28 offen
    buffer_load_dwordx4 v[116:119], v4, s[12:15], s28 offen
    s_cmp_lg_u32 s48, 32
    s_cselect_b32 s48, s48, 0
    s_waitcnt vmcnt(16)
    ds_read_b64_tr_b16 v[128:129], v12 offset:0
    ds_read_b64_tr_b16 v[130:131], v12 offset:512
    ds_read_b64_tr_b16 v[132:133], v13 offset:0
    ds_read_b64_tr_b16 v[134:135], v13 offset:512
    s_waitcnt lgkmcnt(4)
    v_mfma_f32_32x32x16_bf16 v[16:31], v[136:139], v[120:123], v[16:31]
    v_mfma_f32_32x32x16_bf16 v[32:47], v[136:139], v[124:127], v[32:47]
    v_mfma_f32_32x32x16_bf16 v[48:63], v[140:143], v[120:123], v[48:63]
    v_mfma_f32_32x32x16_bf16 v[64:79], v[140:143], v[124:127], v[64:79]
    s_mul_i32 s27, s48, 57344
    s_add_u32 m0, s26, 10240
    s_add_u32 s27, s27, s25
    buffer_load_dwordx4 v5, s[8:11], s27 offen lds
    s_add_u32 m0, s26, 11264
    s_add_u32 s27, s27, 28672
    s_lshl_b32 s28, s48, 10
    buffer_load_dwordx4 v5, s[8:11], s27 offen lds
    s_add_u32 s28, s28, s23
    s_add_u32 s48, s48, 1
    buffer_load_dwordx4 v[120:123], v3, s[12:15], s28 offen
    buffer_load_dwordx4 v[124:127], v4, s[12:15], s28 offen
    s_cmp_lg_u32 s48, 32
    s_cselect_b32 s48, s48, 0
    s_sub_u32 s50, s50, 1
    s_cmp_lg_u32 s50, 0
    s_cbranch_scc1 L_g1_loop
    s_waitcnt vmcnt(16)
    ds_read_b64_tr_b16 v[136:137], v12 offset:2048
    ds_read_b64_tr_b16 v[138:139], v12 offset:2560
    ds_read_b64_tr_b16 v[140:141], v13 offset:2048
    ds_read_b64_tr_b16 v[142:143], v13 offset:2560
    s_waitcnt lgkmcnt(4)
    v_mfma_f32_32x32x16_bf16 v[16:31], v[128:131], v[80:83], v[16:31]
    v_mfma_f32_32x32x16_bf16 v[32:47], v[128:131], v[84:87], v[32:47]
    v_mfma_f32_32x32x16_bf16 v[48:63], v[132:135], v[80:83], v[48:63]
    v_mfma_f32_32x32x16_bf16 v[64:79], v[132:135], v[84:87], v[64:79]
    s_mul_i32 s27, s48, 57344
    s_add_u32 m0, s26, 0
    s_add_u32 s27, s27, s25
    buffer_load_dwordx4 v5, s[8:11], s27 offen lds
    s_add_u32 m0, s26, 1024
    s_add_u32 s27, s27, 28672
    s_lshl_b32 s28, s48, 10
    buffer_load_dwordx4 v5, s[8:11], s27 offen lds
    s_add_u32 s28, s28, s23
    s_add_u32 s48, s48, 1
    buffer_load_dwordx4 v[80:83], v3, s[12:15], s28 offen
    buffer_load_dwordx4 v[84:87], v4, s[12:15], s28 offen
    s_cmp_lg_u32 s48, 32
    s_cselect_b32 s48, s48, 0
    s_waitcnt vmcnt(16)
    ds_read_b64_tr_b16 v[128:129], v12 offset:4096
    ds_read_b64_tr_b16 v[130:131], v12 offset:4608
    ds_read_b64_tr_b16 v[132:133], v13 offset:4096
    ds_read_b64_tr_b16 v[134:135], v13 offset:4608
    s_waitcnt lgkmcnt(4)
    v_mfma_f32_32x32x16_bf16 v[16:31], v[136:139], v[88:91], v[16:31]
    v_mfma_f32_32x32x16_bf16 v[32:47], v[136:139], v[92:95], v[32:47]
    v_mfma_f32_32x32x16_bf16 v[48:63], v[140:143], v[88:91], v[48:63]
    v_mfma_f32_32x32x16_bf16 v[64:79], v[140:143], v[92:95], v[64:79]
    s_mul_i32 s27, s48, 57344
    s_add_u32 m0, s26, 2048
    s_add_u32 s27, s27, s25
    buffer_load_dwordx4 v5, s[8:11], s27 offen lds
    s_add_u32 m0, s26, 3072
    s_add_u32 s27, s27, 28672
    s_lshl_b32 s28, s48, 10
    buffer_load_dwordx4 v5, s[8:11], s27 offen lds
    s_add_u32 s28, s28, s23
    s_add_u32 s48, s48, 1
    buffer_load_dwordx4 v[88:91], v3, s[12:15], s28 offen
    buffer_load_dwordx4 v[92:95], v4, s[12:15], s28 offen
    s_cmp_lg_u32 s48, 32
    s_cselect_b32 s48, s48, 0
    s_waitcnt vmcnt(16)
    ds_read_b64_tr_b16 v[136:137], v12 offset:6144
    ds_read_b64_tr_b16 v[138:139], v12 offset:6656
    ds_read_b64_tr_b16 v[140:141], v13 offset:6144
    ds_read_b64_tr_b16 v[142:143], v13 offset:6656
    s_waitcnt lgkmcnt(4)
    v_mfma_f32_32x32x16_bf16 v[16:31], v[128:131], v[96:99], v[16:31]
    v_mfma_f32_32x32x16_bf16 v[32:47], v[128:131], v[100:103], v[32:47]
    v_mfma_f32_32x32x16_bf16 v[48:63], v[132:135], v[96:99], v[48:63]
    v_mfma_f32_32x32x16_bf16 v[64:79], v[132:135], v[100:103], v[64:79]
    s_waitcnt vmcnt(12)
    ds_read_b64_tr_b16 v[128:129], v12 offset:8192
    ds_read_b64_tr_b16 v[130:131], v12 offset:8704
    ds_read_b64_tr_b16 v[132:133], v13 offset:8192
    ds_read_b64_tr_b16 v[134:135], v13 offset:8704
    s_waitcnt lgkmcnt(4)
    v_mfma_f32_32x32x16_bf16 v[16:31], v[136:139], v[104:107], v[16:31]
    v_mfma_f32_32x32x16_bf16 v[32:47], v[136:139], v[108:111], v[32:47]
    v_mfma_f32_32x32x16_bf16 v[48:63], v[140:143], v[104:107], v[48:63]
    v_mfma_f32_32x32x16_bf16 v[64:79], v[140:143], v[108:111], v[64:79]
    s_waitcnt vmcnt(8)
    ds_read_b64_tr_b16 v[136:137], v12 offset:10240
    ds_read_b64_tr_b16 v[138:139], v12 offset:10752
    ds_read_b64_tr_b16 v[140:141], v13 offset:10240
    ds_read_b64_tr_b16 v[142:143], v13 offset:10752
    s_waitcnt lgkmcnt(4)
    v_mfma_f32_32x32x16_bf16 v[16:31], v[128:131], v[112:115], v[16:31]
    v_mfma_f32_32x32x16_bf16 v[32:47], v[128:131], v[116:119], v[32:47]
    v_mfma_f32_32x32x16_bf16 v[48:63], v[132:135], v[112:115], v[48:63]
    v_mfma_f32_32x32x16_bf16 v[64:79], v[132:135], v[116:119], v[64:79]
    s_waitcnt vmcnt(4)
    ds_read_b64_tr_b16 v[128:129], v12 offset:0
    ds_read_b64_tr_b16 v[130:131], v12 offset:512
    ds_read_b64_tr_b16 v[132:133], v13 offset:0
    ds_read_b64_tr_b16 v[134:135], v13 offset:512
    s_waitcnt lgkmcnt(4)
    v_mfma_f32_32x32x16_bf16 v[16:31], v[136:139], v[120:123], v[16:31]
    v_mfma_f32_32x32x16_bf16 v[32:47], v[136:139], v[124:127], v[32:47]
    v_mfma_f32_32x32x16_bf16 v[48:63], v[140:143], v[120:123], v[48:63]
    v_mfma_f32_32x32x16_bf16 v[64:79], v[140:143], v[124:127], v[64:79]
    s_waitcnt vmcnt(0)
    ds_read_b64_tr_b16 v[136:137], v12 offset:2048
    ds_read_b64_tr_b16 v[138:139], v12 offset:2560
    ds_read_b64_tr_b16 v[140:141], v13 offset:2048
    ds_read_b64_tr_b16 v[142:143], v13 offset:2560
    s_waitcnt lgkmcnt(4)
    v_mfma_f32_32x32x16_bf16 v[16:31], v[128:131], v[80:83], v[16:31]
    v_mfma_f32_32x32x16_bf16 v[32:47], v[128:131], v[84:87], v[32:47]
    v_mfma_f32_32x32x16_bf16 v[48:63], v[132:135], v[80:83], v[48:63]
    v_mfma_f32_32x32x16_bf16 v[64:79], v[132:135], v[84:87], v[64:79]
    s_waitcnt lgkmcnt(0)
    v_mfma_f32_32x32x16_bf16 v[16:31], v[136:139], v[88:91], v[16:31]
    v_mfma_f32_32x32x16_bf16 v[32:47], v[136:139], v[92:95], v[32:47]
    v_mfma_f32_32x32x16_bf16 v[48:63], v[140:143], v[88:91], v[48:63]
    v_mfma_f32_32x32x16_bf16 v[64:79], v[140:143], v[92:95], v[64:79]
    s_mov_b32 s27, 0xffff0000
    s_barrier
    s_nop 3
    s_cmp_eq_u32 s3, 0
    s_cbranch_scc1 L_g1_own0
    s_sub_u32 s28, s3, 1
    s_and_b32 s28, s28, 3
    s_add_u32 s28, s28, 0
    s_lshl_b32 s28, s28, 12
    v_add_u32 v8, s28, v3
    ds_write_b128 v8, v[16:19] offset:0
    ds_write_b128 v8, v[20:23] offset:1024
    ds_write_b128 v8, v[24:27] offset:2048
    ds_write_b128 v8, v[28:31] offset:3072
    s_branch L_g1_nx0
L_g1_own0:
    v_pk_add_f32 v[80:81], v[16:17], 0
    v_pk_add_f32 v[82:83], v[18:19], 0
    v_pk_add_f32 v[84:85], v[20:21], 0
    v_pk_add_f32 v[86:87], v[22:23], 0
    v_pk_add_f32 v[88:89], v[24:25], 0
    v_pk_add_f32 v[90:91], v[26:27], 0
    v_pk_add_f32 v[92:93], v[28:29], 0
    v_pk_add_f32 v[94:95], v[30:31], 0
L_g1_nx0:
    s_cmp_eq_u32 s3, 1
    s_cbranch_scc1 L_g1_own1
    s_sub_u32 s28, s3, 2
    s_and_b32 s28, s28, 3
    s_add_u32 s28, s28, 3
    s_lshl_b32 s28, s28, 12
    v_add_u32 v8, s28, v3
    ds_write_b128 v8, v[32:35] offset:0
    ds_write_b128 v8, v[36:39] offset:1024
    ds_write_b128 v8, v[40:43] offset:2048
    ds_write_b128 v8, v[44:47] offset:3072
    s_branch L_g1_nx1
L_g1_own1:
    v_pk_add_f32 v[80:81], v[32:33], 0
    v_pk_add_f32 v[82:83], v[34:35], 0
    v_pk_add_f32 v[84:85], v[36:37], 0
    v_pk_add_f32 v[86:87], v[38:39], 0
    v_pk_add_f32 v[88:89], v[40:41], 0
    v_pk_add_f32 v[90:91], v[42:43], 0
    v_pk_add_f32 v[92:93], v[44:45], 0
    v_pk_add_f32 v[94:95], v[46:47], 0
L_g1_nx1:
    s_cmp_eq_u32 s3, 2
    s_cbranch_scc1 L_g1_own2
    s_sub_u32 s28, s3, 3
    s_and_b32 s28, s28, 3
    s_add_u32 s28, s28, 6
    s_lshl_b32 s28, s28, 12
    v_add_u32 v8, s28, v3
    ds_write_b128 v8, v[48:51] offset:0
    ds_write_b128 v8, v[52:55] offset:1024
    ds_write_b128 v8, v[56:59] offset:2048
    ds_write_b128 v8, v[60:63] offset:3072
    s_branch L_g1_nx2
L_g1_own2:
    v_pk_add_f32 v[80:81], v[48:49], 0
    v_pk_add_f32 v[82:83], v[50:51], 0
    v_pk_add_f32 v[84:85], v[52:53], 0
    v_pk_add_f32 v[86:87], v[54:55], 0
    v_pk_add_f32 v[88:89], v[56:57], 0
    v_pk_add_f32 v[90:91], v[58:59], 0
    v_pk_add_f32 v[92:93], v[60:61], 0
    v_pk_add_f32 v[94:95], v[62:63], 0
L_g1_nx2:
    s_cmp_eq_u32 s3, 3
    s_cbranch_scc1 L_g1_own3
    s_sub_u32 s28, s3, 4
    s_and_b32 s28, s28, 3
    s_add_u32 s28, s28, 9
    s_lshl_b32 s28, s28, 12
    v_add_u32 v8, s28, v3
    ds_write_b128 v8, v[64:67] offset:0
    ds_write_b128 v8, v[68:71] offset:1024
    ds_write_b128 v8, v[72:75] offset:2048
    ds_write_b128 v8, v[76:79] offset:3072
    s_branch L_g1_nx3
L_g1_own3:
    v_pk_add_f32 v[80:81], v[64:65], 0
    v_pk_add_f32 v[82:83], v[66:67], 0
    v_pk_add_f32 v[84:85], v[68:69], 0
    v_pk_add_f32 v[86:87], v[70:71], 0
    v_pk_add_f32 v[88:89], v[72:73], 0
    v_pk_add_f32 v[90:91], v[74:75], 0
    v_pk_add_f32 v[92:93], v[76:77], 0
    v_pk_add_f32 v[94:95], v[78:79], 0
L_g1_nx3:
    s_mul_i32 s28, s3, 12288
    v_add_u32 v8, s28, v3
    s_lshl_b32 s32, s22, 1
    s_add_u32 s32, s32, s30
    s_mul_i32 s32, s32, 114688
    s_lshl_b32 s33, s21, 12
    s_add_u32 s32, s32, s33
    s_lshl_b32 s33, s29, 11
    s_add_u32 s32, s32, s33
    s_add_u32 s32, s32, 0x400000
    v_lshlrev_b32 v11, 4, v6
    v_lshl_add_u32 v11, v7, 3, v11
    s_waitcnt lgkmcnt(0)
    s_barrier
    ds_read_b128 v[96:99], v8 offset:0
    ds_read_b128 v[112:115], v8 offset:4096
    ds_read_b128 v[128:131], v8 offset:8192
    ds_read_b128 v[100:103], v8 offset:1024
    ds_read_b128 v[116:119], v8 offset:5120
    ds_read_b128 v[132:135], v8 offset:9216
    ds_read_b128 v[104:107], v8 offset:2048
    ds_read_b128 v[120:123], v8 offset:6144
    ds_read_b128 v[136:139], v8 offset:10240
    ds_read_b128 v[108:111], v8 offset:3072
    ds_read_b128 v[124:127], v8 offset:7168
    ds_read_b128 v[140:143], v8 offset:11264
    s_waitcnt vmcnt(0)
    v_mov_b32 v16, 0xc0135761
    v_mov_b32 v17, 0xc0135761
    v_mov_b32 v18, 0xbdd2d3e8
    v_mov_b32 v19, 0xbdd2d3e8
    v_mov_b32 v20, 1.0
    v_mov_b32 v21, 1.0
    s_waitcnt lgkmcnt(6)
    v_pk_add_f32 v[80:81], v[80:81], v[96:97]
    v_pk_add_f32 v[82:83], v[82:83], v[98:99]
    v_pk_add_f32 v[84:85], v[84:85], v[100:101]
    v_pk_add_f32 v[86:87], v[86:87], v[102:103]
    v_pk_add_f32 v[80:81], v[80:81], v[112:113]
    v_pk_add_f32 v[82:83], v[82:83], v[114:115]
    v_pk_add_f32 v[84:85], v[84:85], v[116:117]
    v_pk_add_f32 v[86:87], v[86:87], v[118:119]
    v_pk_add_f32 v[80:81], v[80:81], v[128:129]
    v_pk_add_f32 v[82:83], v[82:83], v[130:131]
    v_pk_add_f32 v[84:85], v[84:85], v[132:133]
    v_pk_add_f32 v[86:87], v[86:87], v[134:135]
    s_waitcnt lgkmcnt(0)
    v_pk_add_f32 v[88:89], v[88:89], v[104:105]
    v_pk_add_f32 v[90:91], v[90:91], v[106:107]
    v_pk_add_f32 v[92:93], v[92:93], v[108:109]
    v_pk_add_f32 v[94:95], v[94:95], v[110:111]
    v_pk_add_f32 v[88:89], v[88:89], v[120:121]
    v_pk_add_f32 v[90:91], v[90:91], v[122:123]
    v_pk_add_f32 v[92:93], v[92:93], v[124:125]
    v_pk_add_f32 v[94:95], v[94:95], v[126:127]
    v_pk_add_f32 v[88:89], v[88:89], v[136:137]
    v_pk_add_f32 v[90:91], v[90:91], v[138:139]
    v_pk_add_f32 v[92:93], v[92:93], v[140:141]
    v_pk_add_f32 v[94:95], v[94:95], v[142:143]
    v_lshlrev_b32 v32, 16, v144
    v_and_b32 v33, s27, v144
    v_lshlrev_b32 v34, 16, v145
    v_and_b32 v35, s27, v145
    v_lshlrev_b32 v36, 16, v146
    v_and_b32 v37, s27, v146
    v_lshlrev_b32 v38, 16, v147
    v_and_b32 v39, s27, v147
    v_lshlrev_b32 v40, 16, v148
    v_and_b32 v41, s27, v148
    v_lshlrev_b32 v42, 16, v149
    v_and_b32 v43, s27, v149
    v_lshlrev_b32 v44, 16, v150
    v_and_b32 v45, s27, v150
    v_lshlrev_b32 v46, 16, v151
    v_and_b32 v47, s27, v151
    v_pk_add_f32 v[80:81], v[80:81], v[32:33]
    v_pk_add_f32 v[82:83], v[82:83], v[34:35]
    v_pk_add_f32 v[84:85], v[84:85], v[36:37]
    v_pk_add_f32 v[86:87], v[86:87], v[38:39]
    v_pk_add_f32 v[88:89], v[88:89], v[40:41]
    v_pk_add_f32 v[90:91], v[90:91], v[42:43]
    v_pk_add_f32 v[92:93], v[92:93], v[44:45]
    v_pk_add_f32 v[94:95], v[94:95], v[46:47]
    v_pk_mul_f32 v[32:33], v[80:81], v[80:81]
    v_pk_mul_f32 v[34:35], v[82:83], v[82:83]
    v_pk_mul_f32 v[36:37], v[84:85], v[84:85]
    v_pk_mul_f32 v[38:39], v[86:87], v[86:87]
    v_pk_mul_f32 v[40:41], v[88:89], v[88:89]
    v_pk_mul_f32 v[42:43], v[90:91], v[90:91]
    v_pk_mul_f32 v[44:45], v[92:93], v[92:93]
    v_pk_mul_f32 v[46:47], v[94:95], v[94:95]
    v_pk_fma_f32 v[32:33], v[32:33], v[18:19], v[16:17]
    v_pk_fma_f32 v[34:35], v[34:35], v[18:19], v[16:17]
    v_pk_fma_f32 v[36:37], v[36:37], v[18:19], v[16:17]
    v_pk_fma_f32 v[38:39], v[38:39], v[18:19], v[16:17]
    v_pk_fma_f32 v[40:41], v[40:41], v[18:19], v[16:17]
    v_pk_fma_f32 v[42:43], v[42:43], v[18:19], v[16:17]
    v_pk_fma_f32 v[44:45], v[44:45], v[18:19], v[16:17]
    v_pk_fma_f32 v[46:47], v[46:47], v[18:19], v[16:17]
    v_pk_mul_f32 v[32:33], v[32:33], v[80:81]
    v_pk_mul_f32 v[34:35], v[34:35], v[82:83]
    v_pk_mul_f32 v[36:37], v[36:37], v[84:85]
    v_pk_mul_f32 v[38:39], v[38:39], v[86:87]
    v_pk_mul_f32 v[40:41], v[40:41], v[88:89]
    v_pk_mul_f32 v[42:43], v[42:43], v[90:91]
    v_pk_mul_f32 v[44:45], v[44:45], v[92:93]
    v_pk_mul_f32 v[46:47], v[46:47], v[94:95]
    v_exp_f32 v32, v32
    v_exp_f32 v33, v33
    v_exp_f32 v34, v34
    v_exp_f32 v35, v35
    v_exp_f32 v36, v36
    v_exp_f32 v37, v37
    v_exp_f32 v38, v38
    v_exp_f32 v39, v39
    v_exp_f32 v40, v40
    v_exp_f32 v41, v41
    v_exp_f32 v42, v42
    v_exp_f32 v43, v43
    v_exp_f32 v44, v44
    v_exp_f32 v45, v45
    v_exp_f32 v46, v46
    v_exp_f32 v47, v47
    v_pk_add_f32 v[32:33], v[32:33], v[20:21]
    v_pk_add_f32 v[34:35], v[34:35], v[20:21]
    v_pk_add_f32 v[36:37], v[36:37], v[20:21]
    v_pk_add_f32 v[38:39], v[38:39], v[20:21]
    v_pk_add_f32 v[40:41], v[40:41], v[20:21]
    v_pk_add_f32 v[42:43], v[42:43], v[20:21]
    v_pk_add_f32 v[44:45], v[44:45], v[20:21]
    v_pk_add_f32 v[46:47], v[46:47], v[20:21]
    v_rcp_f32 v32, v32
    v_rcp_f32 v33, v33
    v_rcp_f32 v34, v34
    v_rcp_f32 v35, v35
    v_rcp_f32 v36, v36
    v_rcp_f32 v37, v37
    v_rcp_f32 v38, v38
    v_rcp_f32 v39, v39
    v_rcp_f32 v40, v40
    v_rcp_f32 v41, v41
    v_rcp_f32 v42, v42
    v_rcp_f32 v43, v43
    v_rcp_f32 v44, v44
    v_rcp_f32 v45, v45
    v_rcp_f32 v46, v46
    v_rcp_f32 v47, v47
    s_nop 0
    v_pk_mul_f32 v[80:81], v[80:81], v[32:33]
    v_pk_mul_f32 v[82:83], v[82:83], v[34:35]
    v_pk_mul_f32 v[84:85], v[84:85], v[36:37]
    v_pk_mul_f32 v[86:87], v[86:87], v[38:39]
    v_pk_mul_f32 v[88:89], v[88:89], v[40:41]
    v_pk_mul_f32 v[90:91], v[90:91], v[42:43]
    v_pk_mul_f32 v[92:93], v[92:93], v[44:45]
    v_pk_mul_f32 v[94:95], v[94:95], v[46:47]
    v_cvt_pk_bf16_f32 v48, v80, v81
    v_cvt_pk_bf16_f32 v49, v82, v83
    v_cvt_pk_bf16_f32 v50, v84, v85
    v_cvt_pk_bf16_f32 v51, v86, v87
    v_cvt_pk_bf16_f32 v52, v88, v89
    v_cvt_pk_bf16_f32 v53, v90, v91
    v_cvt_pk_bf16_f32 v54, v92, v93
    v_cvt_pk_bf16_f32 v55, v94, v95
    buffer_store_dwordx2 v[48:49], v11, s[12:15], s32 offen offset:0
    buffer_store_dwordx2 v[50:51], v11, s[12:15], s32 offen offset:512
    buffer_store_dwordx2 v[52:53], v11, s[12:15], s32 offen offset:1024
    buffer_store_dwordx2 v[54:55], v11, s[12:15], s32 offen offset:1536
    s_endpgm
L_k2_exit:
    s_endpgm
L_k2_conv:
    s_load_dwordx2 s[4:5], s[0:1], 136
    s_load_dwordx2 s[6:7], s[0:1], 96
    s_load_dwordx2 s[42:43], s[0:1], 64
    v_lshrrev_b32 v1, 6, v0
    v_and_b32 v2, 63, v0
    v_readfirstlane_b32 s3, v1
    s_lshl_b32 s25, s2, 1
    v_mov_b32 v6, 0
    v_lshlrev_b32 v3, 4, v0
    s_lshl_b32 s21, s2, 12
    s_add_u32 s20, s21, 0x900000
    s_add_u32 s22, s21, 0x200000
    s_add_u32 s23, s21, 0x600000
    s_waitcnt lgkmcnt(0)
    s_add_u32 s12, s4, s20
    s_addc_u32 s13, s5, 0
    s_mov_b32 s14, 4096
    s_mov_b32 s15, 0x00020000
    buffer_load_dwordx4 v[8:11], v3, s[12:15], 0 offen
    buffer_load_dwordx4 v[12:15], v3, s[12:15], 0 offen offset:16
    s_mov_b32 s8, s4
    s_mov_b32 s9, s5
    s_mov_b32 s10, 0x10000000
    s_mov_b32 s11, 0x00020000
    buffer_load_dwordx4 v[152:155], v3, s[8:11], s22 offen
    s_mov_b32 s16, s42
    s_mov_b32 s17, s43
    s_mov_b32 s18, 0x400
    s_mov_b32 s19, 0x00020000
    v_lshlrev_b32 v7, 5, v0
    s_mov_b32 s24, 0x800000
    buffer_load_dwordx4 v[156:159], v7, s[8:11], s24 offen
    buffer_load_dwordx4 v[160:163], v7, s[8:11], s24 offen offset:16
    buffer_load_ushort v164, v6, s[16:19], s25 offen
    v_mov_b32 v48, 0
    v_mov_b32 v49, 0
    v_mov_b32 v50, 0
    v_mov_b32 v51, 0
    ds_write_b128 v3, v[48:51] offset:35328
    v_lshrrev_b32 v4, 3, v2
    v_mul_u32_u24 v4, 4416, v4
    v_and_b32 v7, 7, v2
    v_lshl_add_u32 v4, v7, 4, v4
    v_add_u32 v4, 4096, v4
    v_add_u32 v5, 39424, v3
    s_cmp_eq_u32 s3, 0
    s_cbranch_scc1 L_cv_z0
    s_cmp_eq_u32 s3, 1
    s_cbranch_scc0 L_cv_z1
    ds_write_b128 v4, v[48:51]
    s_branch L_cv_z1
L_cv_z0:
    s_mov_b32 exec_hi, 0
    ds_write_b128 v5, v[48:51]
    s_mov_b64 exec, -1
L_cv_z1:
    v_lshrrev_b32 v6, 3, v0
    v_mul_u32_u24 v6, 144, v6
    v_and_b32 v7, 7, v0
    v_lshl_add_u32 v6, v7, 4, v6
    v_and_b32 v20, 31, v2
    v_lshrrev_b32 v21, 5, v2
    v_and_b32 v22, 7, v20
    v_sub_u32 v22, 7, v22
    v_mul_u32_u24 v22, 4416, v22
    v_lshrrev_b32 v23, 3, v20
    v_sub_u32 v23, v21, v23
    v_lshl_add_u32 v22, v23, 4, v22
    s_lshl_b32 s28, s3, 9
    s_sub_u32 s30, 3632, s28
    v_add_u32 v18, s30, v22
    v_mul_u32_u24 v23, 144, v20
    v_lshl_add_u32 v23, v21, 4, v23
    s_mul_i32 s29, s3, 576
    s_sub_u32 s30, 39504, s29
    v_add_u32 v19, s30, v23
    v_and_b32 v22, 15, v2
    v_lshrrev_b32 v23, 4, v2
    v_and_b32 v16, 7, v2
    v_sub_u32 v16, 7, v16
    v_mul_u32_u24 v16, 4416, v16
    v_lshrrev_b32 v17, 3, v22
    v_sub_u32 v17, v23, v17
    v_lshl_add_u32 v16, v17, 4, v16
    s_sub_u32 s30, 1552, s28
    v_add_u32 v16, s30, v16
    v_mul_u32_u24 v17, 144, v22
    v_lshl_add_u32 v17, v23, 4, v17
    s_sub_u32 s30, 39504, s29
    v_add_u32 v17, s30, v17
    v_mul_u32_u24 v7, 272, v22
    v_lshl_add_u32 v7, v23, 4, v7
    s_waitcnt vmcnt(4)
    v_mov_b32 v66, v9
    v_mov_b32 v67, v10
    v_mov_b32 v68, v11
    v_mov_b32 v69, v12
    v_mov_b32 v70, v13
    v_mov_b32 v71, v14
    v_mov_b32 v72, v15
    v_alignbit_b32 v74, v9, v8, 16
    v_alignbit_b32 v75, v10, v9, 16
    v_alignbit_b32 v76, v11, v10, 16
    v_alignbit_b32 v77, v12, v11, 16
    v_alignbit_b32 v78, v13, v12, 16
    v_alignbit_b32 v79, v14, v13, 16
    v_alignbit_b32 v80, v15, v14, 16
    v_alignbit_b32 v84, v10, v9, 16
    v_alignbit_b32 v85, v11, v10, 16
    v_alignbit_b32 v86, v12, v11, 16
    v_alignbit_b32 v87, v13, v12, 16
    v_alignbit_b32 v88, v14, v13, 16
    v_alignbit_b32 v89, v15, v14, 16
    ds_write_b128 v3, v[8:11] offset:0
    ds_write_b128 v3, v[74:77] offset:4416
    ds_write_b128 v3, v[66:69] offset:8832
    ds_write_b128 v3, v[84:87] offset:13248
    ds_write_b128 v3, v[10:13] offset:17664
    ds_write_b128 v3, v[76:79] offset:22080
    ds_write_b128 v3, v[68:71] offset:26496
    ds_write_b128 v3, v[86:89] offset:30912
    s_waitcnt vmcnt(3)
    ds_write_b128 v6, v[152:155] offset:39936
    s_waitcnt lgkmcnt(0)
    s_barrier
    ds_read_b128 v[24:27], v18 offset:544
    ds_read_b128 v[28:31], v18 offset:512
    ds_read_b128 v[32:35], v18 offset:480
    ds_read_b128 v[36:39], v18 offset:448
    ds_read_b128 v[40:43], v18 offset:416
    ds_read_b128 v[44:47], v18 offset:384
    ds_read_b128 v[96:99], v19 offset:432
    ds_read_b128 v[100:103], v19 offset:464
    ds_read_b128 v[104:107], v19 offset:496
    ds_read_b128 v[108:111], v19 offset:528
    ds_read_b128 v[48:51], v18 offset:352
    ds_read_b128 v[52:55], v18 offset:320
    ds_read_b128 v[56:59], v18 offset:288
    ds_read_b128 v[60:63], v18 offset:256
    ds_read_b128 v[112:115], v19 offset:288
    ds_read_b128 v[116:119], v19 offset:320
    ds_read_b128 v[120:123], v19 offset:352
    ds_read_b128 v[124:127], v19 offset:384
    s_waitcnt lgkmcnt(8)
    v_mfma_f32_32x32x16_bf16 v[64:79], v[36:39], v[96:99], 0
    v_mfma_f32_32x32x16_bf16 v[80:95], v[44:47], v[96:99], 0
    v_mfma_f32_32x32x16_bf16 v[64:79], v[32:35], v[100:103], v[64:79]
    v_mfma_f32_32x32x16_bf16 v[80:95], v[40:43], v[100:103], v[80:95]
    v_mfma_f32_32x32x16_bf16 v[64:79], v[28:31], v[104:107], v[64:79]
    v_mfma_f32_32x32x16_bf16 v[80:95], v[36:39], v[104:107], v[80:95]
    v_mfma_f32_32x32x16_bf16 v[64:79], v[24:27], v[108:111], v[64:79]
    v_mfma_f32_32x32x16_bf16 v[80:95], v[32:35], v[108:111], v[80:95]
    ds_read_b128 v[24:27], v18 offset:224
    ds_read_b128 v[28:31], v18 offset:192
    ds_read_b128 v[32:35], v18 offset:160
    ds_read_b128 v[36:39], v18 offset:128
    ds_read_b128 v[96:99], v19 offset:144
    ds_read_b128 v[100:103], v19 offset:176
    ds_read_b128 v[104:107], v19 offset:208
    ds_read_b128 v[108:111], v19 offset:240
    s_waitcnt lgkmcnt(8)
    v_mfma_f32_32x32x16_bf16 v[64:79], v[52:55], v[112:115], v[64:79]
    v_mfma_f32_32x32x16_bf16 v[80:95], v[60:63], v[112:115], v[80:95]
    v_mfma_f32_32x32x16_bf16 v[64:79], v[48:51], v[116:119], v[64:79]
    v_mfma_f32_32x32x16_bf16 v[80:95], v[56:59], v[116:119], v[80:95]
    v_mfma_f32_32x32x16_bf16 v[64:79], v[44:47], v[120:123], v[64:79]
    v_mfma_f32_32x32x16_bf16 v[80:95], v[52:55], v[120:123], v[80:95]
    v_mfma_f32_32x32x16_bf16 v[64:79], v[40:43], v[124:127], v[64:79]
    v_mfma_f32_32x32x16_bf16 v[80:95], v[48:51], v[124:127], v[80:95]
    ds_read_b128 v[40:43], v18 offset:96
    ds_read_b128 v[44:47], v18 offset:64
    ds_read_b128 v[48:51], v18 offset:32
    ds_read_b128 v[52:55], v18 offset:0
    ds_read_b128 v[112:115], v19 offset:0
    ds_read_b128 v[116:119], v19 offset:32
    ds_read_b128 v[120:123], v19 offset:64
    ds_read_b128 v[124:127], v19 offset:96
    s_waitcnt lgkmcnt(8)
    v_mfma_f32_32x32x16_bf16 v[64:79], v[28:31], v[96:99], v[64:79]
    v_mfma_f32_32x32x16_bf16 v[80:95], v[36:39], v[96:99], v[80:95]
    v_mfma_f32_32x32x16_bf16 v[64:79], v[24:27], v[100:103], v[64:79]
    v_mfma_f32_32x32x16_bf16 v[80:95], v[32:35], v[100:103], v[80:95]
    v_mfma_f32_32x32x16_bf16 v[64:79], v[60:63], v[104:107], v[64:79]
    v_mfma_f32_32x32x16_bf16 v[80:95], v[28:31], v[104:107], v[80:95]
    v_mfma_f32_32x32x16_bf16 v[64:79], v[56:59], v[108:111], v[64:79]
    v_mfma_f32_32x32x16_bf16 v[80:95], v[24:27], v[108:111], v[80:95]
    ds_read_b128 v[56:59], v16 offset:544
    ds_read_b128 v[60:63], v16 offset:512
    ds_read_b128 v[24:27], v16 offset:480
    ds_read_b128 v[28:31], v16 offset:448
    ds_read_b128 v[96:99], v17 offset:432
    ds_read_b128 v[100:103], v17 offset:496
    s_waitcnt lgkmcnt(6)
    v_mfma_f32_32x32x16_bf16 v[64:79], v[44:47], v[112:115], v[64:79]
    v_mfma_f32_32x32x16_bf16 v[80:95], v[52:55], v[112:115], v[80:95]
    v_mfma_f32_32x32x16_bf16 v[64:79], v[40:43], v[116:119], v[64:79]
    v_mfma_f32_32x32x16_bf16 v[80:95], v[48:51], v[116:119], v[80:95]
    v_mfma_f32_32x32x16_bf16 v[64:79], v[36:39], v[120:123], v[64:79]
    v_mfma_f32_32x32x16_bf16 v[80:95], v[44:47], v[120:123], v[80:95]
    v_mfma_f32_32x32x16_bf16 v[64:79], v[32:35], v[124:127], v[64:79]
    v_mfma_f32_32x32x16_bf16 v[80:95], v[40:43], v[124:127], v[80:95]
    ds_read_b128 v[32:35], v16 offset:416
    ds_read_b128 v[36:39], v16 offset:384
    ds_read_b128 v[40:43], v16 offset:352
    ds_read_b128 v[44:47], v16 offset:320
    ds_read_b128 v[48:51], v16 offset:288
    ds_read_b128 v[52:55], v16 offset:256
    ds_read_b128 v[112:115], v17 offset:288
    ds_read_b128 v[116:119], v17 offset:352
    s_waitcnt lgkmcnt(6)
    v_mfma_f32_16x16x32_bf16 v[136:139], v[24:27], v[96:99], 0
    v_mfma_f32_16x16x32_bf16 v[140:143], v[28:31], v[96:99], 0
    v_mfma_f32_16x16x32_bf16 v[144:147], v[32:35], v[96:99], 0
    v_mfma_f32_16x16x32_bf16 v[148:151], v[36:39], v[96:99], 0
    v_mfma_f32_16x16x32_bf16 v[136:139], v[56:59], v[100:103], v[136:139]
    v_mfma_f32_16x16x32_bf16 v[140:143], v[60:63], v[100:103], v[140:143]
    v_mfma_f32_16x16x32_bf16 v[144:147], v[24:27], v[100:103], v[144:147]
    v_mfma_f32_16x16x32_bf16 v[148:151], v[28:31], v[100:103], v[148:151]
    ds_read_b128 v[56:59], v16 offset:224
    ds_read_b128 v[60:63], v16 offset:192
    ds_read_b128 v[24:27], v16 offset:160
    ds_read_b128 v[28:31], v16 offset:128
    ds_read_b128 v[96:99], v17 offset:144
    ds_read_b128 v[100:103], v17 offset:208
    s_waitcnt lgkmcnt(6)
    v_mfma_f32_16x16x32_bf16 v[136:139], v[40:43], v[112:115], v[136:139]
    v_mfma_f32_16x16x32_bf16 v[140:143], v[44:47], v[112:115], v[140:143]
    v_mfma_f32_16x16x32_bf16 v[144:147], v[48:51], v[112:115], v[144:147]
    v_mfma_f32_16x16x32_bf16 v[148:151], v[52:55], v[112:115], v[148:151]
    v_mfma_f32_16x16x32_bf16 v[136:139], v[32:35], v[116:119], v[136:139]
    v_mfma_f32_16x16x32_bf16 v[140:143], v[36:39], v[116:119], v[140:143]
    v_mfma_f32_16x16x32_bf16 v[144:147], v[40:43], v[116:119], v[144:147]
    v_mfma_f32_16x16x32_bf16 v[148:151], v[44:47], v[116:119], v[148:151]
    ds_read_b128 v[32:35], v16 offset:96
    ds_read_b128 v[36:39], v16 offset:64
    ds_read_b128 v[40:43], v16 offset:32
    ds_read_b128 v[44:47], v16 offset:0
    ds_read_b128 v[112:115], v17 offset:0
    ds_read_b128 v[116:119], v17 offset:64
    s_waitcnt lgkmcnt(6)
    v_mfma_f32_16x16x32_bf16 v[136:139], v[56:59], v[96:99], v[136:139]
    v_mfma_f32_16x16x32_bf16 v[140:143], v[60:63], v[96:99], v[140:143]
    v_mfma_f32_16x16x32_bf16 v[144:147], v[24:27], v[96:99], v[144:147]
    v_mfma_f32_16x16x32_bf16 v[148:151], v[28:31], v[96:99], v[148:151]
    v_mfma_f32_16x16x32_bf16 v[136:139], v[48:51], v[100:103], v[136:139]
    v_mfma_f32_16x16x32_bf16 v[140:143], v[52:55], v[100:103], v[140:143]
    v_mfma_f32_16x16x32_bf16 v[144:147], v[56:59], v[100:103], v[144:147]
    v_mfma_f32_16x16x32_bf16 v[148:151], v[60:63], v[100:103], v[148:151]
    s_waitcnt lgkmcnt(0)
    v_mfma_f32_16x16x32_bf16 v[136:139], v[32:35], v[112:115], v[136:139]
    v_mfma_f32_16x16x32_bf16 v[140:143], v[36:39], v[112:115], v[140:143]
    v_mfma_f32_16x16x32_bf16 v[144:147], v[40:43], v[112:115], v[144:147]
    v_mfma_f32_16x16x32_bf16 v[148:151], v[44:47], v[112:115], v[148:151]
    v_mfma_f32_16x16x32_bf16 v[136:139], v[24:27], v[116:119], v[136:139]
    v_mfma_f32_16x16x32_bf16 v[140:143], v[28:31], v[116:119], v[140:143]
    v_mfma_f32_16x16x32_bf16 v[144:147], v[32:35], v[116:119], v[144:147]
    v_mfma_f32_16x16x32_bf16 v[148:151], v[36:39], v[116:119], v[148:151]
    v_mul_u32_u24 v24, 272, v20
    v_lshl_add_u32 v24, v21, 4, v24
    s_mul_i32 s28, s3, 8704
    v_add_u32 v24, s28, v24
    v_lshrrev_b32 v25, 3, v0
    v_mul_u32_u24 v25, 272, v25
    v_and_b32 v26, 7, v0
    v_lshl_add_u32 v25, v26, 5, v25
    s_mov_b32 s27, 0xffff0000
    s_waitcnt vmcnt(0)
    s_barrier
    s_nop 3
    ds_write_b128 v24, v[64:67] offset:0
    ds_write_b128 v24, v[68:71] offset:32
    ds_write_b128 v24, v[72:75] offset:64
    ds_write_b128 v24, v[76:79] offset:96
    ds_write_b128 v24, v[80:83] offset:128
    ds_write_b128 v24, v[84:87] offset:160
    ds_write_b128 v24, v[88:91] offset:192
    ds_write_b128 v24, v[92:95] offset:224
    s_mul_i32 s29, s3, 4352
    v_add_u32 v7, s29, v7
    ds_write_b128 v7, v[136:139] offset:34816
    ds_write_b128 v7, v[140:143] offset:34880
    ds_write_b128 v7, v[144:147] offset:34944
    ds_write_b128 v7, v[148:151] offset:35008
    v_lshlrev_b32 v164, 16, v164
    v_mov_b32 v165, v164
    v_lshlrev_b32 v128, 16, v152
    v_and_b32 v129, s27, v152
    v_lshlrev_b32 v130, 16, v153
    v_and_b32 v131, s27, v153
    v_lshlrev_b32 v132, 16, v154
    v_and_b32 v133, s27, v154
    v_lshlrev_b32 v134, 16, v155
    v_and_b32 v135, s27, v155
    v_pk_mul_f32 v[128:129], v[128:129], v[164:165]
    v_pk_mul_f32 v[130:131], v[130:131], v[164:165]
    v_pk_mul_f32 v[132:133], v[132:133], v[164:165]
    v_pk_mul_f32 v[134:135], v[134:135], v[164:165]
    s_waitcnt lgkmcnt(0)
    s_barrier
    ds_read_b128 v[32:35], v25 offset:0
    ds_read_b128 v[36:39], v25 offset:16
    ds_read_b128 v[40:43], v25 offset:8704
    ds_read_b128 v[44:47], v25 offset:8720
    ds_read_b128 v[48:51], v25 offset:17408
    ds_read_b128 v[52:55], v25 offset:17424
    ds_read_b128 v[56:59], v25 offset:26112
    ds_read_b128 v[60:63], v25 offset:26128
    s_cmp_lt_u32 s3, 2
    s_cbranch_scc1 L_cv_no16
    ds_read_b128 v[96:99], v25 offset:30464
    ds_read_b128 v[100:103], v25 offset:30480
    ds_read_b128 v[104:107], v25 offset:34816
    ds_read_b128 v[108:111], v25 offset:34832
    ds_read_b128 v[112:115], v25 offset:39168
    ds_read_b128 v[116:119], v25 offset:39184
    ds_read_b128 v[120:123], v25 offset:43520
    ds_read_b128 v[124:127], v25 offset:43536
    s_waitcnt lgkmcnt(0)
    v_pk_add_f32 v[128:129], v[128:129], v[96:97]
    v_pk_add_f32 v[130:131], v[130:131], v[98:99]
    v_pk_add_f32 v[132:133], v[132:133], v[100:101]
    v_pk_add_f32 v[134:135], v[134:135], v[102:103]
    v_pk_add_f32 v[128:129], v[128:129], v[104:105]
    v_pk_add_f32 v[130:131], v[130:131], v[106:107]
    v_pk_add_f32 v[132:133], v[132:133], v[108:109]
    v_pk_add_f32 v[134:135], v[134:135], v[110:111]
    v_pk_add_f32 v[128:129], v[128:129], v[112:113]
    v_pk_add_f32 v[130:131], v[130:131], v[114:115]
    v_pk_add_f32 v[132:133], v[132:133], v[116:117]
    v_pk_add_f32 v[134:135], v[134:135], v[118:119]
    v_pk_add_f32 v[128:129], v[128:129], v[120:121]
    v_pk_add_f32 v[130:131], v[130:131], v[122:123]
    v_pk_add_f32 v[132:133], v[132:133], v[124:125]
    v_pk_add_f32 v[134:135], v[134:135], v[126:127]
L_cv_no16:
    s_waitcnt lgkmcnt(4)
    v_pk_add_f32 v[32:33], v[32:33], v[40:41]
    v_pk_add_f32 v[34:35], v[34:35], v[42:43]
    v_pk_add_f32 v[36:37], v[36:37], v[44:45]
    v_pk_add_f32 v[38:39], v[38:39], v[46:47]
    s_waitcnt lgkmcnt(0)
    v_pk_add_f32 v[48:49], v[48:49], v[56:57]
    v_pk_add_f32 v[50:51], v[50:51], v[58:59]
    v_pk_add_f32 v[52:53], v[52:53], v[60:61]
    v_pk_add_f32 v[54:55], v[54:55], v[62:63]
    v_pk_add_f32 v[32:33], v[32:33], v[48:49]
    v_pk_add_f32 v[34:35], v[34:35], v[50:51]
    v_pk_add_f32 v[36:37], v[36:37], v[52:53]
    v_pk_add_f32 v[38:39], v[38:39], v[54:55]
    v_pk_add_f32 v[32:33], v[32:33], v[128:129]
    v_pk_add_f32 v[34:35], v[34:35], v[130:131]
    v_pk_add_f32 v[36:37], v[36:37], v[132:133]
    v_pk_add_f32 v[38:39], v[38:39], v[134:135]
    v_pk_mul_f32 v[32:33], v[32:33], v[156:157]
    v_pk_mul_f32 v[34:35], v[34:35], v[158:159]
    v_pk_mul_f32 v[36:37], v[36:37], v[160:161]
    v_pk_mul_f32 v[38:39], v[38:39], v[162:163]
    v_cvt_pk_bf16_f32 v72, v32, v33
    v_cvt_pk_bf16_f32 v73, v34, v35
    v_cvt_pk_bf16_f32 v74, v36, v37
    v_cvt_pk_bf16_f32 v75, v38, v39
    buffer_store_dwordx4 v[72:75], v3, s[8:11], s23 offen
    s_endpgm
.globl k3_gemm2_kernel
.p2align 8
.type k3_gemm2_kernel,@function
k3_gemm2_kernel:
    s_cmp_ge_u32 s2, 256
    s_cbranch_scc1 L_k3_exit
    s_load_dwordx2 s[4:5], s[0:1], 96
    s_load_dwordx2 s[6:7], s[0:1], 136
    s_load_dwordx2 s[36:37], s[0:1], 104
    s_load_dwordx2 s[38:39], s[0:1], 120
    v_lshrrev_b32 v1, 6, v0
    v_and_b32 v2, 63, v0
    v_readfirstlane_b32 s3, v1
    s_and_b32 s20, s2, 7
    s_lshr_b32 s21, s2, 3
    s_mul_i32 s20, s20, 32
    s_add_u32 s20, s20, s21
    s_lshr_b32 s21, s20, 3
    s_and_b32 s22, s20, 7
    s_mul_i32 s23, s22, 229376
    s_mul_i32 s24, s3, 28672
    s_add_u32 s23, s23, s24
    s_add_u32 s23, s23, 0x400000
    v_lshlrev_b32 v3, 4, v2
    v_add_u32 v4, 114688, v3
    v_lshrrev_b32 v5, 3, v2
    v_and_b32 v6, 7, v2
    v_lshlrev_b32 v7, 1, v5
    v_and_b32 v7, 4, v7
    v_xor_b32 v6, v6, v7
    v_mul_u32_u24 v5, 4096, v5
    v_lshl_add_u32 v5, v6, 4, v5
    s_lshl_b32 s24, s21, 7
    v_add_u32 v5, s24, v5
    s_mul_i32 s25, s3, 1835008
    s_mul_i32 s26, s3, 16384
    s_waitcnt lgkmcnt(0)
    s_mov_b32 s8, s4
    s_mov_b32 s9, s5
    s_mov_b32 s10, 0x700000
    s_mov_b32 s11, 0x00020000
    s_mov_b32 s12, s6
    s_mov_b32 s13, s7
    s_mov_b32 s14, 0x10000000
    s_mov_b32 s15, 0x00020000
    s_and_b32 s48, s21, 3
    s_lshl2_add_u32 s48, s22, s48
    s_sub_u32 s49, s48, 28
    s_cmp_ge_u32 s48, 28
    s_cselect_b32 s48, s49, s48
    s_mul_i32 s27, s48, 65536
    s_add_u32 m0, s26, 0
    s_add_u32 s27, s27, s25
    buffer_load_dwordx4 v5, s[8:11], s27 offen lds
    s_add_u32 m0, s26, 1024
    s_add_u32 s27, s27, 32768
    s_lshl_b32 s28, s48, 10
    buffer_load_dwordx4 v5, s[8:11], s27 offen lds
    s_add_u32 s28, s28, s23
    s_add_u32 s48, s48, 1
    buffer_load_dwordx4 v[80:83], v3, s[12:15], s28 offen
    buffer_load_dwordx4 v[84:87], v4, s[12:15], s28 offen
    s_cmp_lg_u32 s48, 28
    s_cselect_b32 s48, s48, 0
    s_mul_i32 s27, s48, 65536
    s_add_u32 m0, s26, 2048
    s_add_u32 s27, s27, s25
    buffer_load_dwordx4 v5, s[8:11], s27 offen lds
    s_add_u32 m0, s26, 3072
    s_add_u32 s27, s27, 32768
    s_lshl_b32 s28, s48, 10
    buffer_load_dwordx4 v5, s[8:11], s27 offen lds
    s_add_u32 s28, s28, s23
    s_add_u32 s48, s48, 1
    buffer_load_dwordx4 v[88:91], v3, s[12:15], s28 offen
    buffer_load_dwordx4 v[92:95], v4, s[12:15], s28 offen
    s_cmp_lg_u32 s48, 28
    s_cselect_b32 s48, s48, 0
    s_mov_b32 s40, s36
    s_mov_b32 s41, s37
    s_mov_b32 s42, 0x1000
    s_mov_b32 s43, 0x00020000
    s_mov_b32 s44, s38
    s_mov_b32 s45, s39
    s_mov_b32 s46, 0x200000
    s_mov_b32 s47, 0x00020000
    s_mul_i32 s27, s48, 65536
    s_add_u32 m0, s26, 4096
    s_add_u32 s27, s27, s25
    buffer_load_dwordx4 v5, s[8:11], s27 offen lds
    s_add_u32 m0, s26, 5120
    s_add_u32 s27, s27, 32768
    s_lshl_b32 s28, s48, 10
    buffer_load_dwordx4 v5, s[8:11], s27 offen lds
    s_add_u32 s28, s28, s23
    s_add_u32 s48, s48, 1
    buffer_load_dwordx4 v[96:99], v3, s[12:15], s28 offen
    buffer_load_dwordx4 v[100:103], v4, s[12:15], s28 offen
    s_cmp_lg_u32 s48, 28
    s_cselect_b32 s48, s48, 0
    s_mul_i32 s27, s48, 65536
    s_add_u32 m0, s26, 6144
    s_add_u32 s27, s27, s25
    buffer_load_dwordx4 v5, s[8:11], s27 offen lds
    s_add_u32 m0, s26, 7168
    s_add_u32 s27, s27, 32768
    s_lshl_b32 s28, s48, 10
    buffer_load_dwordx4 v5, s[8:11], s27 offen lds
    s_add_u32 s28, s28, s23
    s_add_u32 s48, s48, 1
    buffer_load_dwordx4 v[104:107], v3, s[12:15], s28 offen
    buffer_load_dwordx4 v[108:111], v4, s[12:15], s28 offen
    s_cmp_lg_u32 s48, 28
    s_cselect_b32 s48, s48, 0
    s_mul_i32 s27, s48, 65536
    s_add_u32 m0, s26, 8192
    s_add_u32 s27, s27, s25
    buffer_load_dwordx4 v5, s[8:11], s27 offen lds
    s_add_u32 m0, s26, 9216
    s_add_u32 s27, s27, 32768
    s_lshl_b32 s28, s48, 10
    buffer_load_dwordx4 v5, s[8:11], s27 offen lds
    s_add_u32 s28, s28, s23
    s_add_u32 s48, s48, 1
    buffer_load_dwordx4 v[112:115], v3, s[12:15], s28 offen
    buffer_load_dwordx4 v[116:119], v4, s[12:15], s28 offen
    s_cmp_lg_u32 s48, 28
    s_cselect_b32 s48, s48, 0
    s_mul_i32 s27, s48, 65536
    s_add_u32 m0, s26, 10240
    s_add_u32 s27, s27, s25
    buffer_load_dwordx4 v5, s[8:11], s27 offen lds
    s_add_u32 m0, s26, 11264
    s_add_u32 s27, s27, 32768
    s_lshl_b32 s28, s48, 10
    buffer_load_dwordx4 v5, s[8:11], s27 offen lds
    s_add_u32 s28, s28, s23
    s_add_u32 s48, s48, 1
    buffer_load_dwordx4 v[120:123], v3, s[12:15], s28 offen
    buffer_load_dwordx4 v[124:127], v4, s[12:15], s28 offen
    s_cmp_lg_u32 s48, 28
    s_cselect_b32 s48, s48, 0
    s_mul_i32 s27, s48, 65536
    s_add_u32 m0, s26, 12288
    s_add_u32 s27, s27, s25
    buffer_load_dwordx4 v5, s[8:11], s27 offen lds
    s_add_u32 m0, s26, 13312
    s_add_u32 s27, s27, 32768
    s_lshl_b32 s28, s48, 10
    buffer_load_dwordx4 v5, s[8:11], s27 offen lds
    s_add_u32 s28, s28, s23
    s_add_u32 s48, s48, 1
    buffer_load_dwordx4 v[128:131], v3, s[12:15], s28 offen
    buffer_load_dwordx4 v[132:135], v4, s[12:15], s28 offen
    s_cmp_lg_u32 s48, 28
    s_cselect_b32 s48, s48, 0
    s_mul_i32 s27, s48, 65536
    s_add_u32 m0, s26, 14336
    s_add_u32 s27, s27, s25
    buffer_load_dwordx4 v5, s[8:11], s27 offen lds
    s_add_u32 m0, s26, 15360
    s_add_u32 s27, s27, 32768
    s_lshl_b32 s28, s48, 10
    buffer_load_dwordx4 v5, s[8:11], s27 offen lds
    s_add_u32 s28, s28, s23
    s_add_u32 s48, s48, 1
    buffer_load_dwordx4 v[136:139], v3, s[12:15], s28 offen
    buffer_load_dwordx4 v[140:143], v4, s[12:15], s28 offen
    s_cmp_lg_u32 s48, 28
    s_cselect_b32 s48, s48, 0
    v_lshrrev_b32 v8, 4, v2
    v_and_b32 v9, 15, v2
    v_lshrrev_b32 v10, 2, v9
    v_and_b32 v11, 3, v9
    v_lshrrev_b32 v12, 1, v8
    v_lshl_add_u32 v12, v12, 3, v10
    v_lshlrev_b32 v12, 7, v12
    v_and_b32 v13, 1, v8
    v_lshlrev_b32 v13, 1, v13
    v_lshrrev_b32 v14, 1, v11
    v_add_u32 v13, v13, v14
    v_lshlrev_b32 v14, 1, v10
    v_and_b32 v14, 4, v14
    v_xor_b32 v13, v13, v14
    v_lshl_add_u32 v12, v13, 4, v12
    v_and_b32 v14, 1, v11
    v_lshl_add_u32 v12, v14, 3, v12
    v_add_u32 v12, s26, v12
    v_xor_b32 v13, 64, v12
    s_lshr_b32 s29, s3, 1
    s_and_b32 s30, s3, 1
    v_and_b32 v6, 31, v2
    v_lshrrev_b32 v7, 5, v2
    s_lshl_b32 s31, s22, 18
    s_lshl_b32 s32, s21, 7
    s_add_u32 s31, s31, s32
    s_add_u32 s31, s31, 0x600000
    s_add_u32 s32, s31, 131072
    v_lshrrev_b32 v14, 3, v0
    v_and_b32 v15, 7, v0
    v_lshlrev_b32 v15, 4, v15
    v_lshl_add_u32 v15, v14, 12, v15
    buffer_load_dwordx4 v[160:163], v15, s[12:15], s31 offen
    buffer_load_dwordx4 v[164:167], v15, s[12:15], s32 offen
    s_lshl_b32 s33, s21, 6
    s_lshl_b32 s34, s30, 5
    s_add_u32 s33, s33, s34
    v_add_u32 v14, s33, v6
    v_lshlrev_b32 v15, 2, v14
    s_mov_b32 s34, 0x800000
    buffer_load_dword v168, v15, s[12:15], s34 offen
    v_lshlrev_b32 v15, 1, v14
    buffer_load_ushort v169, v15, s[40:43], 0 offen
    v_mov_b32 v16, 0
    v_mov_b32 v17, 0
    v_mov_b32 v18, 0
    v_mov_b32 v19, 0
    v_mov_b32 v20, 0
    v_mov_b32 v21, 0
    v_mov_b32 v22, 0
    v_mov_b32 v23, 0
    v_mov_b32 v24, 0
    v_mov_b32 v25, 0
    v_mov_b32 v26, 0
    v_mov_b32 v27, 0
    v_mov_b32 v28, 0
    v_mov_b32 v29, 0
    v_mov_b32 v30, 0
    v_mov_b32 v31, 0
    v_mov_b32 v32, 0
    v_mov_b32 v33, 0
    v_mov_b32 v34, 0
    v_mov_b32 v35, 0
    v_mov_b32 v36, 0
    v_mov_b32 v37, 0
    v_mov_b32 v38, 0
    v_mov_b32 v39, 0
    v_mov_b32 v40, 0
    v_mov_b32 v41, 0
    v_mov_b32 v42, 0
    v_mov_b32 v43, 0
    v_mov_b32 v44, 0
    v_mov_b32 v45, 0
    v_mov_b32 v46, 0
    v_mov_b32 v47, 0
    v_mov_b32 v48, 0
    v_mov_b32 v49, 0
    v_mov_b32 v50, 0
    v_mov_b32 v51, 0
    v_mov_b32 v52, 0
    v_mov_b32 v53, 0
    v_mov_b32 v54, 0
    v_mov_b32 v55, 0
    v_mov_b32 v56, 0
    v_mov_b32 v57, 0
    v_mov_b32 v58, 0
    v_mov_b32 v59, 0
    v_mov_b32 v60, 0
    v_mov_b32 v61, 0
    v_mov_b32 v62, 0
    v_mov_b32 v63, 0
    v_mov_b32 v64, 0
    v_mov_b32 v65, 0
    v_mov_b32 v66, 0
    v_mov_b32 v67, 0
    v_mov_b32 v68, 0
    v_mov_b32 v69, 0
    v_mov_b32 v70, 0
    v_mov_b32 v71, 0
    v_mov_b32 v72, 0
    v_mov_b32 v73, 0
    v_mov_b32 v74, 0
    v_mov_b32 v75, 0
    v_mov_b32 v76, 0
    v_mov_b32 v77, 0
    v_mov_b32 v78, 0
    v_mov_b32 v79, 0
    s_mov_b32 s50, 2
    s_waitcnt vmcnt(32)
    ds_read_b64_tr_b16 v[144:145], v12 offset:0
    ds_read_b64_tr_b16 v[146:147], v12 offset:512
    ds_read_b64_tr_b16 v[148:149], v13 offset:0
    ds_read_b64_tr_b16 v[150:151], v13 offset:512
L_g2_loop:
    s_waitcnt vmcnt(24)
    ds_read_b64_tr_b16 v[152:153], v12 offset:2048
    ds_read_b64_tr_b16 v[154:155], v12 offset:2560
    ds_read_b64_tr_b16 v[156:157], v13 offset:2048
    ds_read_b64_tr_b16 v[158:159], v13 offset:2560
    s_waitcnt lgkmcnt(4)
    v_mfma_f32_32x32x16_bf16 v[16:31], v[80:83], v[144:147], v[16:31]
    v_mfma_f32_32x32x16_bf16 v[48:63], v[84:87], v[144:147], v[48:63]
    v_mfma_f32_32x32x16_bf16 v[32:47], v[80:83], v[148:151], v[32:47]
    v_mfma_f32_32x32x16_bf16 v[64:79], v[84:87], v[148:151], v[64:79]
    s_mul_i32 s27, s48, 65536
    s_add_u32 m0, s26, 0
    s_add_u32 s27, s27, s25
    buffer_load_dwordx4 v5, s[8:11], s27 offen lds
    s_add_u32 m0, s26, 1024
    s_add_u32 s27, s27, 32768
    s_lshl_b32 s28, s48, 10
    buffer_load_dwordx4 v5, s[8:11], s27 offen lds
    s_add_u32 s28, s28, s23
    s_add_u32 s48, s48, 1
    buffer_load_dwordx4 v[80:83], v3, s[12:15], s28 offen
    buffer_load_dwordx4 v[84:87], v4, s[12:15], s28 offen
    s_cmp_lg_u32 s48, 28
    s_cselect_b32 s48, s48, 0
    s_waitcnt vmcnt(24)
    ds_read_b64_tr_b16 v[144:145], v12 offset:4096
    ds_read_b64_tr_b16 v[146:147], v12 offset:4608
    ds_read_b64_tr_b16 v[148:149], v13 offset:4096
    ds_read_b64_tr_b16 v[150:151], v13 offset:4608
    s_waitcnt lgkmcnt(4)
    v_mfma_f32_32x32x16_bf16 v[16:31], v[88:91], v[152:155], v[16:31]
    v_mfma_f32_32x32x16_bf16 v[48:63], v[92:95], v[152:155], v[48:63]
    v_mfma_f32_32x32x16_bf16 v[32:47], v[88:91], v[156:159], v[32:47]
    v_mfma_f32_32x32x16_bf16 v[64:79], v[92:95], v[156:159], v[64:79]
    s_mul_i32 s27, s48, 65536
    s_add_u32 m0, s26, 2048
    s_add_u32 s27, s27, s25
    buffer_load_dwordx4 v5, s[8:11], s27 offen lds
    s_add_u32 m0, s26, 3072
    s_add_u32 s27, s27, 32768
    s_lshl_b32 s28, s48, 10
    buffer_load_dwordx4 v5, s[8:11], s27 offen lds
    s_add_u32 s28, s28, s23
    s_add_u32 s48, s48, 1
    buffer_load_dwordx4 v[88:91], v3, s[12:15], s28 offen
    buffer_load_dwordx4 v[92:95], v4, s[12:15], s28 offen
    s_cmp_lg_u32 s48, 28
    s_cselect_b32 s48, s48, 0
    s_waitcnt vmcnt(24)
    ds_read_b64_tr_b16 v[152:153], v12 offset:6144
    ds_read_b64_tr_b16 v[154:155], v12 offset:6656
    ds_read_b64_tr_b16 v[156:157], v13 offset:6144
    ds_read_b64_tr_b16 v[158:159], v13 offset:6656
    s_waitcnt lgkmcnt(4)
    v_mfma_f32_32x32x16_bf16 v[16:31], v[96:99], v[144:147], v[16:31]
    v_mfma_f32_32x32x16_bf16 v[48:63], v[100:103], v[144:147], v[48:63]
    v_mfma_f32_32x32x16_bf16 v[32:47], v[96:99], v[148:151], v[32:47]
    v_mfma_f32_32x32x16_bf16 v[64:79], v[100:103], v[148:151], v[64:79]
    s_mul_i32 s27, s48, 65536
    s_add_u32 m0, s26, 4096
    s_add_u32 s27, s27, s25
    buffer_load_dwordx4 v5, s[8:11], s27 offen lds
    s_add_u32 m0, s26, 5120
    s_add_u32 s27, s27, 32768
    s_lshl_b32 s28, s48, 10
    buffer_load_dwordx4 v5, s[8:11], s27 offen lds
    s_add_u32 s28, s28, s23
    s_add_u32 s48, s48, 1
    buffer_load_dwordx4 v[96:99], v3, s[12:15], s28 offen
    buffer_load_dwordx4 v[100:103], v4, s[12:15], s28 offen
    s_cmp_lg_u32 s48, 28
    s_cselect_b32 s48, s48, 0
    s_waitcnt vmcnt(24)
    ds_read_b64_tr_b16 v[144:145], v12 offset:8192
    ds_read_b64_tr_b16 v[146:147], v12 offset:8704
    ds_read_b64_tr_b16 v[148:149], v13 offset:8192
    ds_read_b64_tr_b16 v[150:151], v13 offset:8704
    s_waitcnt lgkmcnt(4)
    v_mfma_f32_32x32x16_bf16 v[16:31], v[104:107], v[152:155], v[16:31]
    v_mfma_f32_32x32x16_bf16 v[48:63], v[108:111], v[152:155], v[48:63]
    v_mfma_f32_32x32x16_bf16 v[32:47], v[104:107], v[156:159], v[32:47]
    v_mfma_f32_32x32x16_bf16 v[64:79], v[108:111], v[156:159], v[64:79]
    s_mul_i32 s27, s48, 65536
    s_add_u32 m0, s26, 6144
    s_add_u32 s27, s27, s25
    buffer_load_dwordx4 v5, s[8:11], s27 offen lds
    s_add_u32 m0, s26, 7168
    s_add_u32 s27, s27, 32768
    s_lshl_b32 s28, s48, 10
    buffer_load_dwordx4 v5, s[8:11], s27 offen lds
    s_add_u32 s28, s28, s23
    s_add_u32 s48, s48, 1
    buffer_load_dwordx4 v[104:107], v3, s[12:15], s28 offen
    buffer_load_dwordx4 v[108:111], v4, s[12:15], s28 offen
    s_cmp_lg_u32 s48, 28
    s_cselect_b32 s48, s48, 0
    s_waitcnt vmcnt(24)
    ds_read_b64_tr_b16 v[152:153], v12 offset:10240
    ds_read_b64_tr_b16 v[154:155], v12 offset:10752
    ds_read_b64_tr_b16 v[156:157], v13 offset:10240
    ds_read_b64_tr_b16 v[158:159], v13 offset:10752
    s_waitcnt lgkmcnt(4)
    v_mfma_f32_32x32x16_bf16 v[16:31], v[112:115], v[144:147], v[16:31]
    v_mfma_f32_32x32x16_bf16 v[48:63], v[116:119], v[144:147], v[48:63]
    v_mfma_f32_32x32x16_bf16 v[32:47], v[112:115], v[148:151], v[32:47]
    v_mfma_f32_32x32x16_bf16 v[64:79], v[116:119], v[148:151], v[64:79]
    s_mul_i32 s27, s48, 65536
    s_add_u32 m0, s26, 8192
    s_add_u32 s27, s27, s25
    buffer_load_dwordx4 v5, s[8:11], s27 offen lds
    s_add_u32 m0, s26, 9216
    s_add_u32 s27, s27, 32768
    s_lshl_b32 s28, s48, 10
    buffer_load_dwordx4 v5, s[8:11], s27 offen lds
    s_add_u32 s28, s28, s23
    s_add_u32 s48, s48, 1
    buffer_load_dwordx4 v[112:115], v3, s[12:15], s28 offen
    buffer_load_dwordx4 v[116:119], v4, s[12:15], s28 offen
    s_cmp_lg_u32 s48, 28
    s_cselect_b32 s48, s48, 0
    s_waitcnt vmcnt(24)
    ds_read_b64_tr_b16 v[144:145], v12 offset:12288
    ds_read_b64_tr_b16 v[146:147], v12 offset:12800
    ds_read_b64_tr_b16 v[148:149], v13 offset:12288
    ds_read_b64_tr_b16 v[150:151], v13 offset:12800
    s_waitcnt lgkmcnt(4)
    v_mfma_f32_32x32x16_bf16 v[16:31], v[120:123], v[152:155], v[16:31]
    v_mfma_f32_32x32x16_bf16 v[48:63], v[124:127], v[152:155], v[48:63]
    v_mfma_f32_32x32x16_bf16 v[32:47], v[120:123], v[156:159], v[32:47]
    v_mfma_f32_32x32x16_bf16 v[64:79], v[124:127], v[156:159], v[64:79]
    s_mul_i32 s27, s48, 65536
    s_add_u32 m0, s26, 10240
    s_add_u32 s27, s27, s25
    buffer_load_dwordx4 v5, s[8:11], s27 offen lds
    s_add_u32 m0, s26, 11264
    s_add_u32 s27, s27, 32768
    s_lshl_b32 s28, s48, 10
    buffer_load_dwordx4 v5, s[8:11], s27 offen lds
    s_add_u32 s28, s28, s23
    s_add_u32 s48, s48, 1
    buffer_load_dwordx4 v[120:123], v3, s[12:15], s28 offen
    buffer_load_dwordx4 v[124:127], v4, s[12:15], s28 offen
    s_cmp_lg_u32 s48, 28
    s_cselect_b32 s48, s48, 0
    s_waitcnt vmcnt(24)
    ds_read_b64_tr_b16 v[152:153], v12 offset:14336
    ds_read_b64_tr_b16 v[154:155], v12 offset:14848
    ds_read_b64_tr_b16 v[156:157], v13 offset:14336
    ds_read_b64_tr_b16 v[158:159], v13 offset:14848
    s_waitcnt lgkmcnt(4)
    v_mfma_f32_32x32x16_bf16 v[16:31], v[128:131], v[144:147], v[16:31]
    v_mfma_f32_32x32x16_bf16 v[48:63], v[132:135], v[144:147], v[48:63]
    v_mfma_f32_32x32x16_bf16 v[32:47], v[128:131], v[148:151], v[32:47]
    v_mfma_f32_32x32x16_bf16 v[64:79], v[132:135], v[148:151], v[64:79]
    s_mul_i32 s27, s48, 65536
    s_add_u32 m0, s26, 12288
    s_add_u32 s27, s27, s25
    buffer_load_dwordx4 v5, s[8:11], s27 offen lds
    s_add_u32 m0, s26, 13312
    s_add_u32 s27, s27, 32768
    s_lshl_b32 s28, s48, 10
    buffer_load_dwordx4 v5, s[8:11], s27 offen lds
    s_add_u32 s28, s28, s23
    s_add_u32 s48, s48, 1
    buffer_load_dwordx4 v[128:131], v3, s[12:15], s28 offen
    buffer_load_dwordx4 v[132:135], v4, s[12:15], s28 offen
    s_cmp_lg_u32 s48, 28
    s_cselect_b32 s48, s48, 0
    s_waitcnt vmcnt(24)
    ds_read_b64_tr_b16 v[144:145], v12 offset:0
    ds_read_b64_tr_b16 v[146:147], v12 offset:512
    ds_read_b64_tr_b16 v[148:149], v13 offset:0
    ds_read_b64_tr_b16 v[150:151], v13 offset:512
    s_waitcnt lgkmcnt(4)
    v_mfma_f32_32x32x16_bf16 v[16:31], v[136:139], v[152:155], v[16:31]
    v_mfma_f32_32x32x16_bf16 v[48:63], v[140:143], v[152:155], v[48:63]
    v_mfma_f32_32x32x16_bf16 v[32:47], v[136:139], v[156:159], v[32:47]
    v_mfma_f32_32x32x16_bf16 v[64:79], v[140:143], v[156:159], v[64:79]
    s_mul_i32 s27, s48, 65536
    s_add_u32 m0, s26, 14336
    s_add_u32 s27, s27, s25
    buffer_load_dwordx4 v5, s[8:11], s27 offen lds
    s_add_u32 m0, s26, 15360
    s_add_u32 s27, s27, 32768
    s_lshl_b32 s28, s48, 10
    buffer_load_dwordx4 v5, s[8:11], s27 offen lds
    s_add_u32 s28, s28, s23
    s_add_u32 s48, s48, 1
    buffer_load_dwordx4 v[136:139], v3, s[12:15], s28 offen
    buffer_load_dwordx4 v[140:143], v4, s[12:15], s28 offen
    s_cmp_lg_u32 s48, 28
    s_cselect_b32 s48, s48, 0
    s_sub_u32 s50, s50, 1
    s_cmp_lg_u32 s50, 0
    s_cbranch_scc1 L_g2_loop
    s_waitcnt vmcnt(24)
    ds_read_b64_tr_b16 v[152:153], v12 offset:2048
    ds_read_b64_tr_b16 v[154:155], v12 offset:2560
    ds_read_b64_tr_b16 v[156:157], v13 offset:2048
    ds_read_b64_tr_b16 v[158:159], v13 offset:2560
    s_waitcnt lgkmcnt(4)
    v_mfma_f32_32x32x16_bf16 v[16:31], v[80:83], v[144:147], v[16:31]
    v_mfma_f32_32x32x16_bf16 v[48:63], v[84:87], v[144:147], v[48:63]
    v_mfma_f32_32x32x16_bf16 v[32:47], v[80:83], v[148:151], v[32:47]
    v_mfma_f32_32x32x16_bf16 v[64:79], v[84:87], v[148:151], v[64:79]
    s_mul_i32 s27, s48, 65536
    s_add_u32 m0, s26, 0
    s_add_u32 s27, s27, s25
    buffer_load_dwordx4 v5, s[8:11], s27 offen lds
    s_add_u32 m0, s26, 1024
    s_add_u32 s27, s27, 32768
    s_lshl_b32 s28, s48, 10
    buffer_load_dwordx4 v5, s[8:11], s27 offen lds
    s_add_u32 s28, s28, s23
    s_add_u32 s48, s48, 1
    buffer_load_dwordx4 v[80:83], v3, s[12:15], s28 offen
    buffer_load_dwordx4 v[84:87], v4, s[12:15], s28 offen
    s_cmp_lg_u32 s48, 28
    s_cselect_b32 s48, s48, 0
    s_waitcnt vmcnt(24)
    ds_read_b64_tr_b16 v[144:145], v12 offset:4096
    ds_read_b64_tr_b16 v[146:147], v12 offset:4608
    ds_read_b64_tr_b16 v[148:149], v13 offset:4096
    ds_read_b64_tr_b16 v[150:151], v13 offset:4608
    s_waitcnt lgkmcnt(4)
    v_mfma_f32_32x32x16_bf16 v[16:31], v[88:91], v[152:155], v[16:31]
    v_mfma_f32_32x32x16_bf16 v[48:63], v[92:95], v[152:155], v[48:63]
    v_mfma_f32_32x32x16_bf16 v[32:47], v[88:91], v[156:159], v[32:47]
    v_mfma_f32_32x32x16_bf16 v[64:79], v[92:95], v[156:159], v[64:79]
    s_mul_i32 s27, s48, 65536
    s_add_u32 m0, s26, 2048
    s_add_u32 s27, s27, s25
    buffer_load_dwordx4 v5, s[8:11], s27 offen lds
    s_add_u32 m0, s26, 3072
    s_add_u32 s27, s27, 32768
    s_lshl_b32 s28, s48, 10
    buffer_load_dwordx4 v5, s[8:11], s27 offen lds
    s_add_u32 s28, s28, s23
    s_add_u32 s48, s48, 1
    buffer_load_dwordx4 v[88:91], v3, s[12:15], s28 offen
    buffer_load_dwordx4 v[92:95], v4, s[12:15], s28 offen
    s_cmp_lg_u32 s48, 28
    s_cselect_b32 s48, s48, 0
    s_waitcnt vmcnt(24)
    ds_read_b64_tr_b16 v[152:153], v12 offset:6144
    ds_read_b64_tr_b16 v[154:155], v12 offset:6656
    ds_read_b64_tr_b16 v[156:157], v13 offset:6144
    ds_read_b64_tr_b16 v[158:159], v13 offset:6656
    s_waitcnt lgkmcnt(4)
    v_mfma_f32_32x32x16_bf16 v[16:31], v[96:99], v[144:147], v[16:31]
    v_mfma_f32_32x32x16_bf16 v[48:63], v[100:103], v[144:147], v[48:63]
    v_mfma_f32_32x32x16_bf16 v[32:47], v[96:99], v[148:151], v[32:47]
    v_mfma_f32_32x32x16_bf16 v[64:79], v[100:103], v[148:151], v[64:79]
    s_mul_i32 s27, s48, 65536
    s_add_u32 m0, s26, 4096
    s_add_u32 s27, s27, s25
    buffer_load_dwordx4 v5, s[8:11], s27 offen lds
    s_add_u32 m0, s26, 5120
    s_add_u32 s27, s27, 32768
    s_lshl_b32 s28, s48, 10
    buffer_load_dwordx4 v5, s[8:11], s27 offen lds
    s_add_u32 s28, s28, s23
    s_add_u32 s48, s48, 1
    buffer_load_dwordx4 v[96:99], v3, s[12:15], s28 offen
    buffer_load_dwordx4 v[100:103], v4, s[12:15], s28 offen
    s_cmp_lg_u32 s48, 28
    s_cselect_b32 s48, s48, 0
    s_waitcnt vmcnt(24)
    ds_read_b64_tr_b16 v[144:145], v12 offset:8192
    ds_read_b64_tr_b16 v[146:147], v12 offset:8704
    ds_read_b64_tr_b16 v[148:149], v13 offset:8192
    ds_read_b64_tr_b16 v[150:151], v13 offset:8704
    s_waitcnt lgkmcnt(4)
    v_mfma_f32_32x32x16_bf16 v[16:31], v[104:107], v[152:155], v[16:31]
    v_mfma_f32_32x32x16_bf16 v[48:63], v[108:111], v[152:155], v[48:63]
    v_mfma_f32_32x32x16_bf16 v[32:47], v[104:107], v[156:159], v[32:47]
    v_mfma_f32_32x32x16_bf16 v[64:79], v[108:111], v[156:159], v[64:79]
    s_mul_i32 s27, s48, 65536
    s_add_u32 m0, s26, 6144
    s_add_u32 s27, s27, s25
    buffer_load_dwordx4 v5, s[8:11], s27 offen lds
    s_add_u32 m0, s26, 7168
    s_add_u32 s27, s27, 32768
    s_lshl_b32 s28, s48, 10
    buffer_load_dwordx4 v5, s[8:11], s27 offen lds
    s_add_u32 s28, s28, s23
    s_add_u32 s48, s48, 1
    buffer_load_dwordx4 v[104:107], v3, s[12:15], s28 offen
    buffer_load_dwordx4 v[108:111], v4, s[12:15], s28 offen
    s_cmp_lg_u32 s48, 28
    s_cselect_b32 s48, s48, 0
    s_waitcnt vmcnt(24)
    ds_read_b64_tr_b16 v[152:153], v12 offset:10240
    ds_read_b64_tr_b16 v[154:155], v12 offset:10752
    ds_read_b64_tr_b16 v[156:157], v13 offset:10240
    ds_read_b64_tr_b16 v[158:159], v13 offset:10752
    s_waitcnt lgkmcnt(4)
    v_mfma_f32_32x32x16_bf16 v[16:31], v[112:115], v[144:147], v[16:31]
    v_mfma_f32_32x32x16_bf16 v[48:63], v[116:119], v[144:147], v[48:63]
    v_mfma_f32_32x32x16_bf16 v[32:47], v[112:115], v[148:151], v[32:47]
    v_mfma_f32_32x32x16_bf16 v[64:79], v[116:119], v[148:151], v[64:79]
    s_waitcnt vmcnt(20)
    ds_read_b64_tr_b16 v[144:145], v12 offset:12288
    ds_read_b64_tr_b16 v[146:147], v12 offset:12800
    ds_read_b64_tr_b16 v[148:149], v13 offset:12288
    ds_read_b64_tr_b16 v[150:151], v13 offset:12800
    s_waitcnt lgkmcnt(4)
    v_mfma_f32_32x32x16_bf16 v[16:31], v[120:123], v[152:155], v[16:31]
    v_mfma_f32_32x32x16_bf16 v[48:63], v[124:127], v[152:155], v[48:63]
    v_mfma_f32_32x32x16_bf16 v[32:47], v[120:123], v[156:159], v[32:47]
    v_mfma_f32_32x32x16_bf16 v[64:79], v[124:127], v[156:159], v[64:79]
    s_waitcnt vmcnt(16)
    ds_read_b64_tr_b16 v[152:153], v12 offset:14336
    ds_read_b64_tr_b16 v[154:155], v12 offset:14848
    ds_read_b64_tr_b16 v[156:157], v13 offset:14336
    ds_read_b64_tr_b16 v[158:159], v13 offset:14848
    s_waitcnt lgkmcnt(4)
    v_mfma_f32_32x32x16_bf16 v[16:31], v[128:131], v[144:147], v[16:31]
    v_mfma_f32_32x32x16_bf16 v[48:63], v[132:135], v[144:147], v[48:63]
    v_mfma_f32_32x32x16_bf16 v[32:47], v[128:131], v[148:151], v[32:47]
    v_mfma_f32_32x32x16_bf16 v[64:79], v[132:135], v[148:151], v[64:79]
    s_waitcnt vmcnt(12)
    ds_read_b64_tr_b16 v[144:145], v12 offset:0
    ds_read_b64_tr_b16 v[146:147], v12 offset:512
    ds_read_b64_tr_b16 v[148:149], v13 offset:0
    ds_read_b64_tr_b16 v[150:151], v13 offset:512
    s_waitcnt lgkmcnt(4)
    v_mfma_f32_32x32x16_bf16 v[16:31], v[136:139], v[152:155], v[16:31]
    v_mfma_f32_32x32x16_bf16 v[48:63], v[140:143], v[152:155], v[48:63]
    v_mfma_f32_32x32x16_bf16 v[32:47], v[136:139], v[156:159], v[32:47]
    v_mfma_f32_32x32x16_bf16 v[64:79], v[140:143], v[156:159], v[64:79]
    s_waitcnt vmcnt(8)
    ds_read_b64_tr_b16 v[152:153], v12 offset:2048
    ds_read_b64_tr_b16 v[154:155], v12 offset:2560
    ds_read_b64_tr_b16 v[156:157], v13 offset:2048
    ds_read_b64_tr_b16 v[158:159], v13 offset:2560
    s_waitcnt lgkmcnt(4)
    v_mfma_f32_32x32x16_bf16 v[16:31], v[80:83], v[144:147], v[16:31]
    v_mfma_f32_32x32x16_bf16 v[48:63], v[84:87], v[144:147], v[48:63]
    v_mfma_f32_32x32x16_bf16 v[32:47], v[80:83], v[148:151], v[32:47]
    v_mfma_f32_32x32x16_bf16 v[64:79], v[84:87], v[148:151], v[64:79]
    s_waitcnt vmcnt(4)
    ds_read_b64_tr_b16 v[144:145], v12 offset:4096
    ds_read_b64_tr_b16 v[146:147], v12 offset:4608
    ds_read_b64_tr_b16 v[148:149], v13 offset:4096
    ds_read_b64_tr_b16 v[150:151], v13 offset:4608
    s_waitcnt lgkmcnt(4)
    v_mfma_f32_32x32x16_bf16 v[16:31], v[88:91], v[152:155], v[16:31]
    v_mfma_f32_32x32x16_bf16 v[48:63], v[92:95], v[152:155], v[48:63]
    v_mfma_f32_32x32x16_bf16 v[32:47], v[88:91], v[156:159], v[32:47]
    v_mfma_f32_32x32x16_bf16 v[64:79], v[92:95], v[156:159], v[64:79]
    s_waitcnt vmcnt(0)
    ds_read_b64_tr_b16 v[152:153], v12 offset:6144
    ds_read_b64_tr_b16 v[154:155], v12 offset:6656
    ds_read_b64_tr_b16 v[156:157], v13 offset:6144
    ds_read_b64_tr_b16 v[158:159], v13 offset:6656
    s_waitcnt lgkmcnt(4)
    v_mfma_f32_32x32x16_bf16 v[16:31], v[96:99], v[144:147], v[16:31]
    v_mfma_f32_32x32x16_bf16 v[48:63], v[100:103], v[144:147], v[48:63]
    v_mfma_f32_32x32x16_bf16 v[32:47], v[96:99], v[148:151], v[32:47]
    v_mfma_f32_32x32x16_bf16 v[64:79], v[100:103], v[148:151], v[64:79]
    s_waitcnt lgkmcnt(0)
    v_mfma_f32_32x32x16_bf16 v[16:31], v[104:107], v[152:155], v[16:31]
    v_mfma_f32_32x32x16_bf16 v[48:63], v[108:111], v[152:155], v[48:63]
    v_mfma_f32_32x32x16_bf16 v[32:47], v[104:107], v[156:159], v[32:47]
    v_mfma_f32_32x32x16_bf16 v[64:79], v[108:111], v[156:159], v[64:79]
    s_mov_b32 s27, 0xffff0000
    v_lshrrev_b32 v9, 3, v0
    v_mul_u32_u24 v9, 144, v9
    v_and_b32 v10, 7, v0
    v_lshl_add_u32 v9, v10, 4, v9
    v_add_u32 v9, 65536, v9
    s_waitcnt vmcnt(0)
    ds_write_b128 v9, v[160:163]
    ds_write_b128 v9, v[164:167] offset:4608
    s_barrier
    s_nop 3
    s_cmp_eq_u32 s3, 0
    s_cbranch_scc1 L_g2_own0
    s_sub_u32 s28, s3, 1
    s_and_b32 s28, s28, 3
    s_add_u32 s28, s28, 0
    s_lshl_b32 s28, s28, 12
    v_add_u32 v8, s28, v3
    ds_write_b128 v8, v[16:19] offset:0
    ds_write_b128 v8, v[20:23] offset:1024
    ds_write_b128 v8, v[24:27] offset:2048
    ds_write_b128 v8, v[28:31] offset:3072
    s_branch L_g2_nx0
L_g2_own0:
    v_pk_add_f32 v[80:81], v[16:17], 0
    v_pk_add_f32 v[82:83], v[18:19], 0
    v_pk_add_f32 v[84:85], v[20:21], 0
    v_pk_add_f32 v[86:87], v[22:23], 0
    v_pk_add_f32 v[88:89], v[24:25], 0
    v_pk_add_f32 v[90:91], v[26:27], 0
    v_pk_add_f32 v[92:93], v[28:29], 0
    v_pk_add_f32 v[94:95], v[30:31], 0
L_g2_nx0:
    s_cmp_eq_u32 s3, 1
    s_cbranch_scc1 L_g2_own1
    s_sub_u32 s28, s3, 2
    s_and_b32 s28, s28, 3
    s_add_u32 s28, s28, 3
    s_lshl_b32 s28, s28, 12
    v_add_u32 v8, s28, v3
    ds_write_b128 v8, v[32:35] offset:0
    ds_write_b128 v8, v[36:39] offset:1024
    ds_write_b128 v8, v[40:43] offset:2048
    ds_write_b128 v8, v[44:47] offset:3072
    s_branch L_g2_nx1
L_g2_own1:
    v_pk_add_f32 v[80:81], v[32:33], 0
    v_pk_add_f32 v[82:83], v[34:35], 0
    v_pk_add_f32 v[84:85], v[36:37], 0
    v_pk_add_f32 v[86:87], v[38:39], 0
    v_pk_add_f32 v[88:89], v[40:41], 0
    v_pk_add_f32 v[90:91], v[42:43], 0
    v_pk_add_f32 v[92:93], v[44:45], 0
    v_pk_add_f32 v[94:95], v[46:47], 0
L_g2_nx1:
    s_cmp_eq_u32 s3, 2
    s_cbranch_scc1 L_g2_own2
    s_sub_u32 s28, s3, 3
    s_and_b32 s28, s28, 3
    s_add_u32 s28, s28, 6
    s_lshl_b32 s28, s28, 12
    v_add_u32 v8, s28, v3
    ds_write_b128 v8, v[48:51] offset:0
    ds_write_b128 v8, v[52:55] offset:1024
    ds_write_b128 v8, v[56:59] offset:2048
    ds_write_b128 v8, v[60:63] offset:3072
    s_branch L_g2_nx2
L_g2_own2:
    v_pk_add_f32 v[80:81], v[48:49], 0
    v_pk_add_f32 v[82:83], v[50:51], 0
    v_pk_add_f32 v[84:85], v[52:53], 0
    v_pk_add_f32 v[86:87], v[54:55], 0
    v_pk_add_f32 v[88:89], v[56:57], 0
    v_pk_add_f32 v[90:91], v[58:59], 0
    v_pk_add_f32 v[92:93], v[60:61], 0
    v_pk_add_f32 v[94:95], v[62:63], 0
L_g2_nx2:
    s_cmp_eq_u32 s3, 3
    s_cbranch_scc1 L_g2_own3
    s_sub_u32 s28, s3, 4
    s_and_b32 s28, s28, 3
    s_add_u32 s28, s28, 9
    s_lshl_b32 s28, s28, 12
    v_add_u32 v8, s28, v3
    ds_write_b128 v8, v[64:67] offset:0
    ds_write_b128 v8, v[68:71] offset:1024
    ds_write_b128 v8, v[72:75] offset:2048
    ds_write_b128 v8, v[76:79] offset:3072
    s_branch L_g2_nx3
L_g2_own3:
    v_pk_add_f32 v[80:81], v[64:65], 0
    v_pk_add_f32 v[82:83], v[66:67], 0
    v_pk_add_f32 v[84:85], v[68:69], 0
    v_pk_add_f32 v[86:87], v[70:71], 0
    v_pk_add_f32 v[88:89], v[72:73], 0
    v_pk_add_f32 v[90:91], v[74:75], 0
    v_pk_add_f32 v[92:93], v[76:77], 0
    v_pk_add_f32 v[94:95], v[78:79], 0
L_g2_nx3:
    s_mul_i32 s28, s3, 12288
    v_add_u32 v8, s28, v3
    v_lshrrev_b32 v9, 4, v2
    v_and_b32 v10, 15, v2
    v_lshrrev_b32 v13, 2, v10
    v_lshl_add_u32 v13, v7, 2, v13
    v_mul_u32_u24 v13, 144, v13
    v_and_b32 v10, 3, v10
    v_lshl_add_u32 v13, v10, 3, v13
    v_and_b32 v9, 1, v9
    v_lshl_add_u32 v13, v9, 5, v13
    s_mul_i32 s32, s29, 4608
    s_lshl_b32 s33, s30, 6
    s_add_u32 s32, s32, s33
    s_add_u32 s32, s32, 65536
    v_add_u32 v13, s32, v13
    v_lshlrev_b32 v14, 10, v14
    v_lshl_add_u32 v14, v7, 3, v14
    s_lshl_b32 s33, s22, 7
    s_lshl_b32 s34, s29, 6
    s_add_u32 s33, s33, s34
    s_waitcnt lgkmcnt(0)
    s_barrier
    ds_read_b128 v[96:99], v8 offset:0
    ds_read_b128 v[112:115], v8 offset:4096
    ds_read_b128 v[128:131], v8 offset:8192
    ds_read_b128 v[100:103], v8 offset:1024
    ds_read_b128 v[116:119], v8 offset:5120
    ds_read_b128 v[132:135], v8 offset:9216
    ds_read_b128 v[104:107], v8 offset:2048
    ds_read_b128 v[120:123], v8 offset:6144
    ds_read_b128 v[136:139], v8 offset:10240
    ds_read_b128 v[108:111], v8 offset:3072
    ds_read_b128 v[124:127], v8 offset:7168
    ds_read_b128 v[140:143], v8 offset:11264
    ds_read_b64_tr_b16 v[16:17], v13 offset:0
    ds_read_b64_tr_b16 v[18:19], v13 offset:1152
    ds_read_b64_tr_b16 v[20:21], v13 offset:2304
    ds_read_b64_tr_b16 v[22:23], v13 offset:3456
    v_lshlrev_b32 v169, 16, v169
    v_sub_f32 v168, 1.0, v168
    v_cvt_pk_bf16_f32 v168, v168, v168
    v_lshlrev_b32 v168, 16, v168
    v_mov_b32 v171, v169
    v_mov_b32 v170, v169
    v_mov_b32 v169, v168
    s_waitcnt lgkmcnt(10)
    v_pk_add_f32 v[80:81], v[80:81], v[96:97]
    v_pk_add_f32 v[82:83], v[82:83], v[98:99]
    v_pk_add_f32 v[84:85], v[84:85], v[100:101]
    v_pk_add_f32 v[86:87], v[86:87], v[102:103]
    v_pk_add_f32 v[80:81], v[80:81], v[112:113]
    v_pk_add_f32 v[82:83], v[82:83], v[114:115]
    v_pk_add_f32 v[84:85], v[84:85], v[116:117]
    v_pk_add_f32 v[86:87], v[86:87], v[118:119]
    v_pk_add_f32 v[80:81], v[80:81], v[128:129]
    v_pk_add_f32 v[82:83], v[82:83], v[130:131]
    v_pk_add_f32 v[84:85], v[84:85], v[132:133]
    v_pk_add_f32 v[86:87], v[86:87], v[134:135]
    s_waitcnt lgkmcnt(4)
    v_pk_add_f32 v[88:89], v[88:89], v[104:105]
    v_pk_add_f32 v[90:91], v[90:91], v[106:107]
    v_pk_add_f32 v[92:93], v[92:93], v[108:109]
    v_pk_add_f32 v[94:95], v[94:95], v[110:111]
    v_pk_add_f32 v[88:89], v[88:89], v[120:121]
    v_pk_add_f32 v[90:91], v[90:91], v[122:123]
    v_pk_add_f32 v[92:93], v[92:93], v[124:125]
    v_pk_add_f32 v[94:95], v[94:95], v[126:127]
    v_pk_add_f32 v[88:89], v[88:89], v[136:137]
    v_pk_add_f32 v[90:91], v[90:91], v[138:139]
    v_pk_add_f32 v[92:93], v[92:93], v[140:141]
    v_pk_add_f32 v[94:95], v[94:95], v[142:143]
    v_pk_add_f32 v[80:81], v[80:81], v[170:171]
    v_pk_add_f32 v[82:83], v[82:83], v[170:171]
    v_pk_add_f32 v[84:85], v[84:85], v[170:171]
    v_pk_add_f32 v[86:87], v[86:87], v[170:171]
    v_pk_add_f32 v[88:89], v[88:89], v[170:171]
    v_pk_add_f32 v[90:91], v[90:91], v[170:171]
    v_pk_add_f32 v[92:93], v[92:93], v[170:171]
    v_pk_add_f32 v[94:95], v[94:95], v[170:171]
    s_waitcnt lgkmcnt(0)
    v_lshlrev_b32 v32, 16, v16
    v_and_b32 v33, s27, v16
    v_lshlrev_b32 v34, 16, v17
    v_and_b32 v35, s27, v17
    v_lshlrev_b32 v36, 16, v18
    v_and_b32 v37, s27, v18
    v_lshlrev_b32 v38, 16, v19
    v_and_b32 v39, s27, v19
    v_lshlrev_b32 v40, 16, v20
    v_and_b32 v41, s27, v20
    v_lshlrev_b32 v42, 16, v21
    v_and_b32 v43, s27, v21
    v_lshlrev_b32 v44, 16, v22
    v_and_b32 v45, s27, v22
    v_lshlrev_b32 v46, 16, v23
    v_and_b32 v47, s27, v23
    v_pk_fma_f32 v[80:81], v[80:81], v[168:169], v[32:33]
    v_pk_fma_f32 v[82:83], v[82:83], v[168:169], v[34:35]
    v_pk_fma_f32 v[84:85], v[84:85], v[168:169], v[36:37]
    v_pk_fma_f32 v[86:87], v[86:87], v[168:169], v[38:39]
    v_pk_fma_f32 v[88:89], v[88:89], v[168:169], v[40:41]
    v_pk_fma_f32 v[90:91], v[90:91], v[168:169], v[42:43]
    v_pk_fma_f32 v[92:93], v[92:93], v[168:169], v[44:45]
    v_pk_fma_f32 v[94:95], v[94:95], v[168:169], v[46:47]
    v_cvt_pk_bf16_f32 v48, v80, v81
    v_cvt_pk_bf16_f32 v49, v82, v83
    v_cvt_pk_bf16_f32 v50, v84, v85
    v_cvt_pk_bf16_f32 v51, v86, v87
    v_cvt_pk_bf16_f32 v52, v88, v89
    v_cvt_pk_bf16_f32 v53, v90, v91
    v_cvt_pk_bf16_f32 v54, v92, v93
    v_cvt_pk_bf16_f32 v55, v94, v95
    buffer_store_dwordx2 v[48:49], v14, s[44:47], s33 offen offset:0
    buffer_store_dwordx2 v[50:51], v14, s[44:47], s33 offen offset:16
    buffer_store_dwordx2 v[52:53], v14, s[44:47], s33 offen offset:32
    buffer_store_dwordx2 v[54:55], v14, s[44:47], s33 offen offset:48
    s_endpgm
L_k3_exit:
    s_endpgm
.section .rodata,"a"
.p2align 6
.amdhsa_kernel k1_prep_kernel
  .amdhsa_next_free_vgpr 144
  .amdhsa_next_free_sgpr 102
  .amdhsa_accum_offset 144
  .amdhsa_group_segment_fixed_size 0
  .amdhsa_kernarg_size 144
  .amdhsa_user_sgpr_count 2
  .amdhsa_user_sgpr_kernarg_segment_ptr 1
  .amdhsa_system_sgpr_workgroup_id_x 1
.end_amdhsa_kernel

.p2align 6
.amdhsa_kernel k2_gemm1_conv_kernel
  .amdhsa_next_free_vgpr 168
  .amdhsa_next_free_sgpr 102
  .amdhsa_accum_offset 168
  .amdhsa_group_segment_fixed_size 0
  .amdhsa_kernarg_size 144
  .amdhsa_user_sgpr_count 2
  .amdhsa_user_sgpr_kernarg_segment_ptr 1
  .amdhsa_system_sgpr_workgroup_id_x 1
.end_amdhsa_kernel

.p2align 6
.amdhsa_kernel k3_gemm2_kernel
  .amdhsa_next_free_vgpr 176
  .amdhsa_next_free_sgpr 102
  .amdhsa_accum_offset 176
  .amdhsa_group_segment_fixed_size 0
  .amdhsa_kernarg_size 144
  .amdhsa_user_sgpr_count 2
  .amdhsa_user_sgpr_kernarg_segment_ptr 1
  .amdhsa_system_sgpr_workgroup_id_x 1
.end_amdhsa_kernel
```
